```python
import torch

def _softmax(x, axis=-1):
    return torch.softmax(x, dim=axis)
def _gelu(x):
    return torch.nn.functional.gelu(x, approximate="tanh")
def _silu(x):
    return torch.nn.functional.silu(x)
def _sigmoid(x):
    return torch.sigmoid(x)
def _layernorm(x, axis=-1, eps=1e-5):
    m = x.mean(dim=axis, keepdim=True)
    v = x.var(dim=axis, keepdim=True, unbiased=False)
    return (x - m) / torch.sqrt(v + eps)
def _scatter_add(tgt, idx, src, axis=0):
    return tgt.clone().index_add_(axis, idx, src)
def _segment_sum(src, seg, n):
    out = torch.zeros((n,) + src.shape[1:], dtype=src.dtype)
    return out.index_add_(0, seg, src)
def _pad(x, pw):
    flat = tuple(v for pair in reversed(pw) for v in pair)
    return torch.nn.functional.pad(x, flat)

kernel_name = 'concat_heads__ssm_conv_s4d__ssm_conv_s4__prompt'

def setup_inputs():

    _w = (lambda a: (lambda t: t.to(torch.bfloat16) if t.is_floating_point() else t)(torch.as_tensor(a)))
    def _A_setup():
        Bsz, L, D, N = 1, 2048, 640, 192
        return {
            "u": _w((lambda *s: torch.randn(*s, dtype=torch.bfloat16) * 0.05)(Bsz, L, D)),
            "log_A_real": _w((lambda *s: torch.randn(*s, dtype=torch.bfloat16) * 6.4)(D, N) * 0.5),
            "A_imag": _w((lambda *s: torch.randn(*s, dtype=torch.bfloat16) * 0.05)(D, N) * 3.14),
            "C_real": _w((lambda *s: torch.randn(*s, dtype=torch.bfloat16) * 0.05)(D, N) / N ** 0.5),
            "C_imag": _w((lambda *s: torch.randn(*s, dtype=torch.bfloat16) * 0.05)(D, N) / N ** 0.5),
            "log_dt": _w((lambda *s: torch.randn(*s, dtype=torch.bfloat16) * 0.05)(D) * 0.5 - 4.0),
            "D_skip": _w((lambda *s: torch.randn(*s, dtype=torch.bfloat16) * 0.05)(D)),
        }
    _A_in = _A_setup()

    def _B_setup():
        B, L, D, N = 1, 2048, 640, 192
        A_re = -(lambda _x: torch.exp(torch.as_tensor(_x)))((lambda *s: torch.randn(*s, dtype=torch.bfloat16) * 6.4)(D, N))
        A_im = torch.pi * (lambda *s: torch.randn(*s, dtype=torch.bfloat16) * 0.05)(D, N)
        B_re = (lambda *s: torch.randn(*s, dtype=torch.bfloat16) * 0.05)(D, N)
        B_im = (lambda *s: torch.randn(*s, dtype=torch.bfloat16) * 0.05)(D, N)
        C_re = (lambda *s: torch.randn(*s, dtype=torch.bfloat16) * 0.05)(D, N)
        C_im = (lambda *s: torch.randn(*s, dtype=torch.bfloat16) * 0.05)(D, N)
        log_dt = (lambda *s: torch.randn(*s, dtype=torch.bfloat16) * 0.05)(D) * 0.5 - 4.0
        Dskip = (lambda *s: torch.randn(*s, dtype=torch.bfloat16) * 0.05)(D)
        return {
            "u": _w((lambda *s: torch.randn(*s, dtype=torch.bfloat16) * 0.05)(B, L, D)),
            "A_re": _w(A_re),
            "A_im": _w(A_im),
            "B_re": _w(B_re),
            "B_im": _w(B_im),
            "C_re": _w(C_re),
            "C_im": _w(C_im),
            "log_dt": _w(log_dt),
            "Dskip": _w(Dskip),
        }
    _B_in = _B_setup()

    return {
        "A_u": _A_in["u"],
        "A_log_A_real": _A_in["log_A_real"],
        "A_A_imag": _A_in["A_imag"],
        "A_C_real": _A_in["C_real"],
        "A_C_imag": _A_in["C_imag"],
        "A_log_dt": _A_in["log_dt"],
        "A_D_skip": _A_in["D_skip"],
        "B_u": _B_in["u"],
        "B_A_re": _B_in["A_re"],
        "B_A_im": _B_in["A_im"],
        "B_B_re": _B_in["B_re"],
        "B_B_im": _B_in["B_im"],
        "B_C_re": _B_in["C_re"],
        "B_C_im": _B_in["C_im"],
        "B_log_dt": _B_in["log_dt"],
        "B_Dskip": _B_in["Dskip"],
    }

def reference(A_u, A_log_A_real, A_A_imag, A_C_real, A_C_imag, A_log_dt, A_D_skip, B_u, B_A_re, B_A_im, B_B_re, B_B_im, B_C_re, B_C_im, B_log_dt, B_Dskip):
    def _A_ref(u, log_A_real, A_imag, C_real, C_imag, log_dt, D_skip):
        L = u.shape[1]
        dt = torch.exp(log_dt)
        A = -torch.exp(log_A_real) + 1j * A_imag
        C = (C_real + 1j * C_imag) * dt[:, None]
        pos = (lambda x, dt: x.to(dt))(torch.arange(L), log_dt.dtype)
        P = torch.exp((A * dt[:, None])[:, :, None] * pos[None, None, :])
        K = 2.0 * torch.einsum("dn,dnl->dl", C, P).real
        L2 = 2 * L
        u_t = (lambda x, *d: x.permute(*d))(u, 0, 2, 1)
        Kf = (lambda x, *a, **k: torch.fft.rfft(x.float(), *a, **k))(K, L2)
        Uf = (lambda x, *a, **k: torch.fft.rfft(x.float(), *a, **k))(u_t, L2)
        y = (lambda x, *a, **k: torch.fft.irfft(x, *a, **k).to(torch.bfloat16))(Uf * Kf[None, :, :], L2)[:, :, :L]
        y = (lambda x, *d: x.permute(*d))(y, 0, 2, 1)
        return y + u * D_skip[None, None, :]

    def _B_ref(u, A_re, A_im, B_re, B_im, C_re, C_im, log_dt, Dskip):
        Bsz, L, D = u.shape
        dt = torch.exp(log_dt)[:, None]
        A = A_re + 1j * A_im
        Bc = B_re + 1j * B_im
        Cc = C_re + 1j * C_im
        logdA = dt * A
        dB = dt * Bc
        l = (lambda x, dt: x.to(dt))(torch.arange(L), A_re.dtype)
        P = torch.exp(logdA[:, :, None] * l[None, None, :])
        K = torch.einsum("dn,dnl,dn->dl", Cc, P, dB).real
        L2 = 2 * L
        Kp = _pad(K, ((0, 0), (0, L)))
        up = (lambda x, *d: x.permute(*d))(u, 0, 2, 1)
        up = _pad(up, ((0, 0), (0, 0), (0, L)))
        Kf = (lambda x, axes=(-2,-1): torch.fft.rfft2(x.float(), dim=axes))(Kp[:, None, :], axes=(-2, -1))
        Uf = (lambda x, axes=(-2,-1): torch.fft.rfft2(x.float(), dim=axes))(up[:, :, None, :], axes=(-2, -1))
        Yf = Uf * Kf[None, :, :, :]
        y = (lambda x, s, axes=(-2,-1): torch.fft.irfft2(x, s=s, dim=axes).to(torch.bfloat16))(Yf, (1, L2), axes=(-2, -1))[:, :, 0, :L]
        y = (lambda x, *d: x.permute(*d))(y, 0, 2, 1) + u * Dskip[None, None, :]
        return y

    a = _A_ref(A_u, A_log_A_real, A_A_imag, A_C_real, A_C_imag, A_log_dt, A_D_skip)
    b = _B_ref(B_u, B_A_re, B_A_im, B_B_re, B_B_im, B_C_re, B_C_im, B_log_dt, B_Dskip)
    return torch.concatenate([a, b], axis=-1)
```

```asm
; @launch grid=(240,1,1) block=(512,1,1) lds=161856
.amdgcn_target "amdgcn-amd-amdhsa--gfx950"
.text
.globl concat_heads__ssm_conv_s4d__ssm_conv_s4__prompt_kernel
.p2align 8
.type concat_heads__ssm_conv_s4d__ssm_conv_s4__prompt_kernel,@function
concat_heads__ssm_conv_s4d__ssm_conv_s4__prompt_kernel:
    s_cmp_ge_u32 s2, 240
    s_cbranch_scc1 L_end
    s_lshr_b32 s7, s2, 3
    s_mul_i32 s8, s7, 43
    s_lshr_b32 s8, s8, 8
    s_and_b32 s4, s2, 7
    s_mul_i32 s4, s4, 5
    s_add_u32 s4, s4, s8
    s_cmp_ge_u32 s4, 20
    s_cselect_b32 s6, 56, 0
    s_cselect_b32 s5, 1280, 0
    s_load_dwordx16 s[16:31], s[0:1], s6
    s_load_dwordx4 s[32:35], s[0:1], 120
    s_getpc_b64 s[54:55]
L_pc:
    v_lshlrev_b32 v100, 6, v0
    v_min_u32 v100, L_end-L_pc, v100
    v_mov_b32 v103, s55
    v_add_co_u32 v102, vcc, s54, v100
    s_nop 1
    v_addc_co_u32 v103, vcc, 0, v103, vcc
    global_load_dword v104, v[102:103], off
    s_mul_i32 s9, s8, 6
    s_sub_u32 s9, s7, s9
    s_mul_i32 s12, s9, 12
    s_sub_u32 s12, s12, 8
    s_lshl_b32 s13, s9, 3
    s_cmp_lt_u32 s9, 2
    s_cselect_b32 s12, s13, s12
    s_cselect_b32 s59, -1, 0
    s_lshl_b32 s4, s4, 6
    s_add_u32 s4, s4, s12
    s_sub_u32 s5, s4, s5
    v_lshrrev_b32 v80, 6, v0
    v_and_b32 v1, 63, v0
    v_readfirstlane_b32 s3, v80
    v_and_b32 v2, 15, v1
    v_lshrrev_b32 v3, 4, v1
    s_sub_u32 s15, s3, 2
    s_cmp_ge_u32 s3, 6
    s_cselect_b32 s15, s15, s3
    s_lshl_b32 s14, s15, 1
    s_add_u32 s14, s14, s5
    s_mul_i32 s13, s14, 192
    v_lshl_add_u32 v80, v1, 2, s13
    v_lshl_add_u32 v81, v1, 1, s13
    v_mov_b32 v82, s14
    v_mov_b32 v225, 0
    v_mov_b32 v227, 0
    v_mov_b32 v229, 0
    v_mov_b32 v231, 0
    v_mov_b32 v233, 0
    v_mov_b32 v235, 0
    s_mul_i32 s12, s9, 21
    s_mul_i32 s8, s8, 10
    s_add_u32 s12, s12, s8
    s_lshr_b32 s8, s3, 2
    s_xor_b32 s42, s8, 1
    s_lshl_b32 s12, s12, s42
    s_lshr_b32 s42, 255, s8
    v_add_u32 v83, s12, v0
    v_and_b32 v83, s42, v83
    v_lshlrev_b32 v83, s8, v83
    v_lshlrev_b32 v7, 3, v83
    v_add_u32 v7, 127200, v7
    v_mul_u32_u24 v83, 5120, v83
    v_add_u32 v4, s5, v83
    s_waitcnt lgkmcnt(0)
    s_cmp_lg_u32 s6, 0
    s_cbranch_scc1 L_ldB
    global_load_ushort v236, v82, s[26:27]
    s_cmp_ge_u32 s3, 6
    s_cbranch_scc1 L_l1a
    global_load_dword v224, v80, s[18:19]
    global_load_dword v226, v80, s[20:21]
    global_load_dword v228, v80, s[22:23]
    global_load_dword v230, v80, s[24:25]
    global_load_ushort v237, v82, s[28:29]
    s_cmp_ge_u32 s3, 4
    s_cbranch_scc1 L_ldU
L_l1a:
    global_load_short_d16_hi v225, v81, s[18:19] offset:256
    global_load_short_d16_hi v227, v81, s[20:21] offset:256
    global_load_short_d16_hi v229, v81, s[22:23] offset:256
    global_load_short_d16_hi v231, v81, s[24:25] offset:256
    s_branch L_ldU
L_ldB:
    global_load_ushort v236, v82, s[30:31]
    s_cmp_ge_u32 s3, 6
    s_cbranch_scc1 L_l1b
    global_load_dword v224, v80, s[18:19]
    global_load_dword v226, v80, s[20:21]
    global_load_dword v228, v80, s[26:27]
    global_load_dword v230, v80, s[28:29]
    global_load_dword v232, v80, s[22:23]
    global_load_dword v234, v80, s[24:25]
    global_load_ushort v237, v82, s[32:33]
    s_cmp_ge_u32 s3, 4
    s_cbranch_scc1 L_ldU
L_l1b:
    global_load_short_d16_hi v225, v81, s[18:19] offset:256
    global_load_short_d16_hi v227, v81, s[20:21] offset:256
    global_load_short_d16_hi v229, v81, s[26:27] offset:256
    global_load_short_d16_hi v231, v81, s[28:29] offset:256
    global_load_short_d16_hi v233, v81, s[22:23] offset:256
    global_load_short_d16_hi v235, v81, s[24:25] offset:256
L_ldU:
    s_barrier
    s_cmp_ge_u32 s3, 4
    s_cbranch_scc1 L_nua
    global_load_dwordx3 v[24:26], v4, s[16:17] offset:0
    global_load_dwordx3 v[28:30], v4, s[16:17] offset:1280
    global_load_dwordx3 v[32:34], v4, s[16:17] offset:2560
    global_load_dwordx3 v[36:38], v4, s[16:17] offset:3840
L_nua:
    s_mul_i32 s36, s3, 8768
    s_mul_i32 s37, s3, 5984
    s_add_u32 s56, s37, 10400
    s_add_u32 s37, s37, 70144
    s_mul_i32 s40, s15, 5984
    s_add_u32 s40, s40, 70144
    s_mul_i32 s41, s15, 4576
    s_add_u32 s41, s41, 126720
    s_mul_i32 s57, s15, 8768
    s_mov_b32 m0, s36
    v_mov_b32 v128, 0
    v_mov_b32 v129, 0
    v_mov_b32 v130, 0
    v_mov_b32 v131, 0
    v_mov_b32 v132, 0
    v_mov_b32 v133, 0
    v_mov_b32 v134, 0
    v_mov_b32 v135, 0
    v_mov_b32 v136, 0
    v_mov_b32 v137, 0
    v_mov_b32 v138, 0
    v_mov_b32 v139, 0
    v_mov_b32 v140, 0
    v_mov_b32 v141, 0
    v_mov_b32 v142, 0
    v_mov_b32 v143, 0
    s_mov_b32 s42, 159296
    v_lshl_add_u32 v0, v1, 2, s42
    ds_write_b32 v0, v128
    v_lshl_add_u32 v85, v1, 3, s41
    s_mov_b32 exec_hi, 0x0fffffff
    ds_write_b64 v85, v[128:129]
    s_mov_b32 exec_hi, -1
    v_mov_b32 v85, 0x3f80
    ds_write_addtid_b32 v85
    v_lshlrev_b32 v87, 4, v1
    v_add_u32 v20, 154176, v87
    s_cmp_gt_u32 s3, 4
    s_cbranch_scc1 L_nomask
    s_lshl_b32 s42, s3, 1
    s_sub_u32 s42, 9, s42
    s_add_u32 s43, s3, 4
    s_bfm_b32 s42, s42, s43
    s_cmp_eq_u32 s3, 3
    s_cselect_b32 s42, 0x3800, s42
    s_cmp_eq_u32 s3, 4
    s_cselect_b32 s42, 0x3000, s42
    s_cselect_b32 s43, -1, 0x3f803f80
    s_mov_b32 s52, 0xffff
    v_lshlrev_b32 v84, 3, v3
    v_lshlrev_b32 v85, v2, s42
    v_lshrrev_b32 v85, v84, v85
    v_bfe_i32 v86, v85, 0, 1
    v_bfe_i32 v83, v85, 1, 1
    v_bfi_b32 v88, s52, v86, v83
    v_and_b32 v88, s43, v88
    v_bfe_i32 v86, v85, 2, 1
    v_bfe_i32 v83, v85, 3, 1
    v_bfi_b32 v89, s52, v86, v83
    v_and_b32 v89, s43, v89
    v_bfe_i32 v86, v85, 4, 1
    v_bfe_i32 v83, v85, 5, 1
    v_bfi_b32 v90, s52, v86, v83
    v_and_b32 v90, s43, v90
    v_bfe_i32 v86, v85, 6, 1
    v_bfe_i32 v83, v85, 7, 1
    v_bfi_b32 v91, s52, v86, v83
    v_and_b32 v91, s43, v91
    s_lshl_b32 s42, s3, 10
    v_add_u32 v85, s42, v20
    ds_write_b128 v85, v[88:91]
L_nomask:
    s_mov_b32 s38, 0x05040100
    s_mov_b32 s39, 0x07060302
    v_and_b32 v80, 31, v1
    v_lshrrev_b32 v81, 5, v1
    v_lshl_add_u32 v82, v81, 4, s36
    v_mul_u32_u24 v5, 272, v80
    v_add_u32 v5, v5, v82
    s_mov_b32 s44, 0xa8d614af
    s_mov_b32 s45, 0x7bab15a
    v_subrev_u32 v83, 20, v80
    v_mul_u32_u24 v83, 5, v83
    v_lshrrev_b64 v[84:85], v83, s[44:45]
    v_cmp_gt_u32 s[46:47], 20, v80
    v_cmp_ne_u32 s[48:49], 5, v80
    v_and_b32 v86, 30, v80
    v_cmp_ne_u32 s[50:51], 12, v86
    v_and_b32 v84, 31, v84
    v_cndmask_b32 v83, v84, v80, s[46:47]
    v_cndmask_b32 v83, 4, v83, s[48:49]
    v_cndmask_b32 v83, 7, v83, s[50:51]
    v_mul_u32_u24 v6, 272, v83
    v_lshl_add_u32 v82, v81, 4, s37
    v_add_u32 v6, v6, v82
    s_and_b32 s42, s3, 1
    s_cmp_lt_u32 s3, 4
    s_cselect_b32 s43, s3, s42
    s_lshl_b32 s58, s43, 9
    s_add_u32 s58, s58, 159808
    s_lshl_b32 s43, s43, 2
    v_add_u32 v75, s43, v0
    v_mov_b32 v74, 1
    s_mul_i32 s43, s42, 9152
    s_add_u32 s43, s43, 129248
    v_add_u32 v12, s43, v87
    s_mul_i32 s43, s42, 11968
    s_add_u32 s43, s43, 106048
    s_sub_u32 s33, s43, 56000
    s_sub_u32 s43, s43, s36
    s_cmp_lt_u32 s3, 2
    s_cselect_b32 s32, 52608, s43
    v_lshlrev_b32 v76, 6, v81
    v_lshl_add_u32 v76, v1, 1, v76
    v_sub_u32 v9, s40, v76
    v_add_u32 v9, 190, v9
    v_sub_u32 v8, s40, v87
    v_add_u32 v8, 1328, v8
    v_lshlrev_b32 v76, 2, v1
    v_sub_u32 v10, s40, v76
    v_add_u32 v10, 2844, v10
    v_lshl_add_u32 v77, v3, 4, s40
    v_lshlrev_b32 v76, 1, v2
    v_sub_u32 v78, v77, v76
    v_and_b32 v79, 1, v2
    v_mul_u32_u24 v79, 1090, v79
    v_sub_u32 v79, v78, v79
    v_add_u32 v16, 1392, v79
    v_add_u32 v17, 1456, v79
    v_sub_u32 v78, v78, v76
    v_add_u32 v18, 60, v78
    v_lshl_add_u32 v77, v3, 4, v77
    v_lshlrev_b32 v76, 3, v2
    v_sub_u32 v78, v77, v76
    v_add_u32 v19, 2584, v78
    v_lshl_add_u32 v77, v3, 4, s41
    v_lshl_add_u32 v11, v2, 5, v77
    v_lshl_add_u32 v77, v3, 3, s57
    v_mad_u32_u24 v13, v2, 40, v77
    v_lshrrev_b32 v76, 2, v2
    v_mul_u32_u24 v76, 8768, v76
    v_and_b32 v77, 3, v2
    v_lshl_add_u32 v76, v77, 3, v76
    v_mad_u32_u24 v76, v3, 40, v76
    s_mul_i32 s43, s42, 320
    v_add_u32 v14, s43, v76
    s_mul_i32 s43, s42, 327680
    s_add_u32 s43, s43, s4
    v_mul_u32_u24 v76, 2560, v1
    v_add_u32 v15, s43, v76
    s_add_u32 s54, s34, 163840
    s_addc_u32 s55, s35, 0
    v_mul_u32_u24 v76, 1088, v3
    v_min_u32 v76, 2464, v76
    v_lshl_add_u32 v76, v2, 4, v76
    v_add_u32 v22, s40, v76
    s_waitcnt vmcnt(4)
    s_cmp_lt_u32 s3, 4
    s_cbranch_scc1 L_pw
    s_waitcnt vmcnt(0)
L_pw:
    v_lshlrev_b32 v80, 16, v236
    v_mul_f32 v80, 0x3fb8aa3b, v80
    v_exp_f32 v80, v80
    v_lshlrev_b32 v21, 16, v237
    v_cvt_pk_bf16_f32 v80, v80, v80
    v_and_b32 v80, 0xffff0000, v80
    v_mul_f32 v81, 0x3fb8aa3b, v80
    v_mul_f32 v82, 0x3e22f983, v80
    v_cmp_eq_u32 vcc, 0, v1
    v_lshlrev_b32 v238, 16, v224
    v_and_b32 v239, 0xffff0000, v224
    v_lshlrev_b32 v240, 16, v226
    v_and_b32 v241, 0xffff0000, v226
    v_lshlrev_b32 v242, 16, v228
    v_and_b32 v243, 0xffff0000, v228
    v_lshlrev_b32 v244, 16, v230
    v_and_b32 v245, 0xffff0000, v230
    v_cndmask_b32 v21, 0, v21, vcc
    v_mul_f32 v57, v240, v82
    v_mul_f32 v61, v241, v82
    v_mul_f32 v65, v227, v82
    s_cmp_lg_u32 s6, 0
    s_cbranch_scc1 L_prepB
    v_add_f32 v80, v80, v80
    v_mul_f32 v84, 0x3fb8aa3b, v238
    v_mul_f32 v85, 0x3fb8aa3b, v239
    v_mul_f32 v86, 0x3fb8aa3b, v225
    v_exp_f32 v84, v84
    v_exp_f32 v85, v85
    v_exp_f32 v86, v86
    v_mul_f32 v58, v242, v80
    v_mul_f32 v59, v244, v80
    v_mul_f32 v62, v243, v80
    v_mul_f32 v63, v245, v80
    v_mul_f32 v66, v229, v80
    v_mul_f32 v67, v231, v80
    v_cvt_pk_bf16_f32 v84, v84, v84
    v_and_b32 v84, 0xffff0000, v84
    v_mul_f32 v56, -v84, v81
    v_cvt_pk_bf16_f32 v85, v85, v85
    v_and_b32 v85, 0xffff0000, v85
    v_mul_f32 v60, -v85, v81
    v_cvt_pk_bf16_f32 v86, v86, v86
    v_and_b32 v86, 0xffff0000, v86
    v_mul_f32 v64, -v86, v81
    s_branch L_prepDone
L_prepB:
    v_lshlrev_b32 v246, 16, v232
    v_and_b32 v247, 0xffff0000, v232
    v_lshlrev_b32 v248, 16, v234
    v_and_b32 v249, 0xffff0000, v234
    v_mul_f32 v56, v238, v81
    v_mul_f32 v246, v246, v80
    v_mul_f32 v248, v248, v80
    v_mul_f32 v58, v242, v246
    v_mul_f32 v59, v242, v248
    v_fma_f32 v58, -v244, v248, v58
    v_fma_f32 v59, v244, v246, v59
    v_mul_f32 v60, v239, v81
    v_mul_f32 v247, v247, v80
    v_mul_f32 v249, v249, v80
    v_mul_f32 v62, v243, v247
    v_mul_f32 v63, v243, v249
    v_fma_f32 v62, -v245, v249, v62
    v_fma_f32 v63, v245, v247, v63
    v_mul_f32 v64, v225, v81
    v_mul_f32 v233, v233, v80
    v_mul_f32 v235, v235, v80
    v_mul_f32 v66, v229, v233
    v_mul_f32 v67, v229, v235
    v_fma_f32 v66, -v231, v235, v66
    v_fma_f32 v67, v231, v233, v67
L_prepDone:
    s_cmp_lt_u32 s3, 6
    s_cbranch_scc1 L_nomv
    v_mov_b32 v56, v64
    v_mov_b32 v57, v65
    v_mov_b32 v58, v66
    v_mov_b32 v59, v67
L_nomv:
    v_mul_f32 v81, 0x41000000, v65
    v_mul_f32 v80, 0x41000000, v64
    v_fract_f32 v81, v81
    v_exp_f32 v80, v80
    v_cos_f32 v72, v81
    v_sin_f32 v73, v81
    v_fract_f32 v83, v65
    v_mul_f32 v72, v72, v80
    v_mul_f32 v73, v73, v80
    v_lshl_add_u32 v84, v1, 3, s58
    s_cmp_ge_u32 s3, 4
    s_cbranch_scc1 L_noz
    ds_write_b64 v84, v[72:73]
L_noz:
    v_mul_f32 v81, 0x41000000, v57
    v_mul_f32 v80, 0x41000000, v56
    v_fract_f32 v81, v81
    v_exp_f32 v80, v80
    v_cos_f32 v68, v81
    v_sin_f32 v69, v81
    v_fract_f32 v83, v57
    v_mul_f32 v68, v68, v80
    v_mul_f32 v69, v69, v80
    v_exp_f32 v82, v56
    v_cos_f32 v70, v83
    v_sin_f32 v71, v83
    v_mul_f32 v70, v70, v82
    v_mul_f32 v71, v71, v82
    s_waitcnt lgkmcnt(0)
    s_barrier
    s_and_b32 s42, s59, s3
    s_cmp_ge_u32 s42, 6
    s_cbranch_scc1 L_hi
    s_cmp_ge_u32 s42, 4
    s_cbranch_scc1 L_nst
    v_cvt_pk_bf16_f32 v89, v68, v69
    ds_write_addtid_b32 v89 offset:272
    v_pk_mul_f32 v[112:113], v[68:69], v[68:69] op_sel_hi:[1,0]
    v_pk_fma_f32 v[112:113], v[68:69], v[68:69], v[112:113] op_sel:[1,1,0] op_sel_hi:[0,1,1] neg_lo:[1,0,0]
    v_cvt_pk_bf16_f32 v90, v112, v113
    ds_write_addtid_b32 v90 offset:544
    v_pk_mul_f32 v[114:115], v[112:113], v[68:69] op_sel_hi:[1,0]
    v_pk_fma_f32 v[114:115], v[112:113], v[68:69], v[114:115] op_sel:[1,1,0] op_sel_hi:[0,1,1] neg_lo:[1,0,0]
    v_cvt_pk_bf16_f32 v91, v114, v115
    ds_write_addtid_b32 v91 offset:816
    v_pk_mul_f32 v[112:113], v[114:115], v[68:69] op_sel_hi:[1,0]
    v_pk_fma_f32 v[112:113], v[114:115], v[68:69], v[112:113] op_sel:[1,1,0] op_sel_hi:[0,1,1] neg_lo:[1,0,0]
    v_cvt_pk_bf16_f32 v92, v112, v113
    ds_write_addtid_b32 v92 offset:1088
    v_pk_mul_f32 v[114:115], v[112:113], v[68:69] op_sel_hi:[1,0]
    v_pk_fma_f32 v[114:115], v[112:113], v[68:69], v[114:115] op_sel:[1,1,0] op_sel_hi:[0,1,1] neg_lo:[1,0,0]
    v_cvt_pk_bf16_f32 v93, v114, v115
    ds_write_addtid_b32 v93 offset:1360
    v_pk_mul_f32 v[112:113], v[114:115], v[68:69] op_sel_hi:[1,0]
    v_pk_fma_f32 v[112:113], v[114:115], v[68:69], v[112:113] op_sel:[1,1,0] op_sel_hi:[0,1,1] neg_lo:[1,0,0]
    v_cvt_pk_bf16_f32 v94, v112, v113
    ds_write_addtid_b32 v94 offset:1632
    v_pk_mul_f32 v[114:115], v[112:113], v[68:69] op_sel_hi:[1,0]
    v_pk_fma_f32 v[114:115], v[112:113], v[68:69], v[114:115] op_sel:[1,1,0] op_sel_hi:[0,1,1] neg_lo:[1,0,0]
    v_cvt_pk_bf16_f32 v95, v114, v115
    ds_write_addtid_b32 v95 offset:1904
    v_pk_mul_f32 v[112:113], v[114:115], v[68:69] op_sel_hi:[1,0]
    v_pk_fma_f32 v[112:113], v[114:115], v[68:69], v[112:113] op_sel:[1,1,0] op_sel_hi:[0,1,1] neg_lo:[1,0,0]
    v_cvt_pk_bf16_f32 v96, v112, v113
    ds_write_addtid_b32 v96 offset:2176
    v_pk_mul_f32 v[114:115], v[112:113], v[68:69] op_sel_hi:[1,0]
    v_pk_fma_f32 v[114:115], v[112:113], v[68:69], v[114:115] op_sel:[1,1,0] op_sel_hi:[0,1,1] neg_lo:[1,0,0]
    v_cvt_pk_bf16_f32 v97, v114, v115
    ds_write_addtid_b32 v97 offset:2448
    v_pk_mul_f32 v[112:113], v[114:115], v[68:69] op_sel_hi:[1,0]
    v_pk_fma_f32 v[112:113], v[114:115], v[68:69], v[112:113] op_sel:[1,1,0] op_sel_hi:[0,1,1] neg_lo:[1,0,0]
    v_cvt_pk_bf16_f32 v98, v112, v113
    ds_write_addtid_b32 v98 offset:2720
    v_pk_mul_f32 v[114:115], v[112:113], v[68:69] op_sel_hi:[1,0]
    v_pk_fma_f32 v[114:115], v[112:113], v[68:69], v[114:115] op_sel:[1,1,0] op_sel_hi:[0,1,1] neg_lo:[1,0,0]
    v_cvt_pk_bf16_f32 v99, v114, v115
    ds_write_addtid_b32 v99 offset:2992
    v_pk_mul_f32 v[112:113], v[114:115], v[68:69] op_sel_hi:[1,0]
    v_pk_fma_f32 v[112:113], v[114:115], v[68:69], v[112:113] op_sel:[1,1,0] op_sel_hi:[0,1,1] neg_lo:[1,0,0]
    v_cvt_pk_bf16_f32 v100, v112, v113
    ds_write_addtid_b32 v100 offset:3264
    v_pk_mul_f32 v[114:115], v[112:113], v[68:69] op_sel_hi:[1,0]
    v_pk_fma_f32 v[114:115], v[112:113], v[68:69], v[114:115] op_sel:[1,1,0] op_sel_hi:[0,1,1] neg_lo:[1,0,0]
    v_cvt_pk_bf16_f32 v101, v114, v115
    ds_write_addtid_b32 v101 offset:3536
    v_pk_mul_f32 v[112:113], v[114:115], v[68:69] op_sel_hi:[1,0]
    v_pk_fma_f32 v[112:113], v[114:115], v[68:69], v[112:113] op_sel:[1,1,0] op_sel_hi:[0,1,1] neg_lo:[1,0,0]
    v_cvt_pk_bf16_f32 v102, v112, v113
    ds_write_addtid_b32 v102 offset:3808
    v_pk_mul_f32 v[114:115], v[112:113], v[68:69] op_sel_hi:[1,0]
    v_pk_fma_f32 v[114:115], v[112:113], v[68:69], v[114:115] op_sel:[1,1,0] op_sel_hi:[0,1,1] neg_lo:[1,0,0]
    v_cvt_pk_bf16_f32 v103, v114, v115
    ds_write_addtid_b32 v103 offset:4080
    v_pk_mul_f32 v[112:113], v[114:115], v[68:69] op_sel_hi:[1,0]
    v_pk_fma_f32 v[112:113], v[114:115], v[68:69], v[112:113] op_sel:[1,1,0] op_sel_hi:[0,1,1] neg_lo:[1,0,0]
    v_cvt_pk_bf16_f32 v88, v112, v113
    ds_write_addtid_b32 v88 offset:4352
    v_pk_mul_f32 v[114:115], v[112:113], v[68:69] op_sel_hi:[1,0]
    v_pk_fma_f32 v[114:115], v[112:113], v[68:69], v[114:115] op_sel:[1,1,0] op_sel_hi:[0,1,1] neg_lo:[1,0,0]
    v_cvt_pk_bf16_f32 v89, v114, v115
    ds_write_addtid_b32 v89 offset:4624
    v_pk_mul_f32 v[112:113], v[114:115], v[68:69] op_sel_hi:[1,0]
    v_pk_fma_f32 v[112:113], v[114:115], v[68:69], v[112:113] op_sel:[1,1,0] op_sel_hi:[0,1,1] neg_lo:[1,0,0]
    v_cvt_pk_bf16_f32 v90, v112, v113
    ds_write_addtid_b32 v90 offset:4896
    v_pk_mul_f32 v[114:115], v[112:113], v[68:69] op_sel_hi:[1,0]
    v_pk_fma_f32 v[114:115], v[112:113], v[68:69], v[114:115] op_sel:[1,1,0] op_sel_hi:[0,1,1] neg_lo:[1,0,0]
    v_cvt_pk_bf16_f32 v91, v114, v115
    ds_write_addtid_b32 v91 offset:5168
    v_pk_mul_f32 v[112:113], v[114:115], v[68:69] op_sel_hi:[1,0]
    v_pk_fma_f32 v[112:113], v[114:115], v[68:69], v[112:113] op_sel:[1,1,0] op_sel_hi:[0,1,1] neg_lo:[1,0,0]
    v_cvt_pk_bf16_f32 v92, v112, v113
    ds_write_addtid_b32 v92 offset:5440
    v_pk_mul_f32 v[114:115], v[112:113], v[68:69] op_sel_hi:[1,0]
    v_pk_fma_f32 v[114:115], v[112:113], v[68:69], v[114:115] op_sel:[1,1,0] op_sel_hi:[0,1,1] neg_lo:[1,0,0]
    v_cvt_pk_bf16_f32 v93, v114, v115
    ds_write_addtid_b32 v93 offset:5712
    v_pk_mul_f32 v[112:113], v[114:115], v[68:69] op_sel_hi:[1,0]
    v_pk_fma_f32 v[112:113], v[114:115], v[68:69], v[112:113] op_sel:[1,1,0] op_sel_hi:[0,1,1] neg_lo:[1,0,0]
    v_cvt_pk_bf16_f32 v94, v112, v113
    ds_write_addtid_b32 v94 offset:5984
    v_pk_mul_f32 v[114:115], v[112:113], v[68:69] op_sel_hi:[1,0]
    v_pk_fma_f32 v[114:115], v[112:113], v[68:69], v[114:115] op_sel:[1,1,0] op_sel_hi:[0,1,1] neg_lo:[1,0,0]
    v_cvt_pk_bf16_f32 v95, v114, v115
    ds_write_addtid_b32 v95 offset:6256
    v_pk_mul_f32 v[112:113], v[114:115], v[68:69] op_sel_hi:[1,0]
    v_pk_fma_f32 v[112:113], v[114:115], v[68:69], v[112:113] op_sel:[1,1,0] op_sel_hi:[0,1,1] neg_lo:[1,0,0]
    v_cvt_pk_bf16_f32 v96, v112, v113
    ds_write_addtid_b32 v96 offset:6528
    v_pk_mul_f32 v[114:115], v[112:113], v[68:69] op_sel_hi:[1,0]
    v_pk_fma_f32 v[114:115], v[112:113], v[68:69], v[114:115] op_sel:[1,1,0] op_sel_hi:[0,1,1] neg_lo:[1,0,0]
    v_cvt_pk_bf16_f32 v97, v114, v115
    ds_write_addtid_b32 v97 offset:6800
    v_pk_mul_f32 v[112:113], v[114:115], v[68:69] op_sel_hi:[1,0]
    v_pk_fma_f32 v[112:113], v[114:115], v[68:69], v[112:113] op_sel:[1,1,0] op_sel_hi:[0,1,1] neg_lo:[1,0,0]
    v_cvt_pk_bf16_f32 v98, v112, v113
    ds_write_addtid_b32 v98 offset:7072
    v_pk_mul_f32 v[114:115], v[112:113], v[68:69] op_sel_hi:[1,0]
    v_pk_fma_f32 v[114:115], v[112:113], v[68:69], v[114:115] op_sel:[1,1,0] op_sel_hi:[0,1,1] neg_lo:[1,0,0]
    v_cvt_pk_bf16_f32 v99, v114, v115
    ds_write_addtid_b32 v99 offset:7344
    v_pk_mul_f32 v[112:113], v[114:115], v[68:69] op_sel_hi:[1,0]
    v_pk_fma_f32 v[112:113], v[114:115], v[68:69], v[112:113] op_sel:[1,1,0] op_sel_hi:[0,1,1] neg_lo:[1,0,0]
    v_cvt_pk_bf16_f32 v100, v112, v113
    ds_write_addtid_b32 v100 offset:7616
    v_pk_mul_f32 v[114:115], v[112:113], v[68:69] op_sel_hi:[1,0]
    v_pk_fma_f32 v[114:115], v[112:113], v[68:69], v[114:115] op_sel:[1,1,0] op_sel_hi:[0,1,1] neg_lo:[1,0,0]
    v_cvt_pk_bf16_f32 v101, v114, v115
    ds_write_addtid_b32 v101 offset:7888
    v_pk_mul_f32 v[112:113], v[114:115], v[68:69] op_sel_hi:[1,0]
    v_pk_fma_f32 v[112:113], v[114:115], v[68:69], v[112:113] op_sel:[1,1,0] op_sel_hi:[0,1,1] neg_lo:[1,0,0]
    v_cvt_pk_bf16_f32 v102, v112, v113
    ds_write_addtid_b32 v102 offset:8160
    v_pk_mul_f32 v[114:115], v[112:113], v[68:69] op_sel_hi:[1,0]
    v_pk_fma_f32 v[114:115], v[112:113], v[68:69], v[114:115] op_sel:[1,1,0] op_sel_hi:[0,1,1] neg_lo:[1,0,0]
    v_cvt_pk_bf16_f32 v103, v114, v115
    ds_write_addtid_b32 v103 offset:8432
    v_pk_mul_f32 v[72:73], v[114:115], v[68:69] op_sel_hi:[1,0]
    v_pk_fma_f32 v[72:73], v[114:115], v[68:69], v[72:73] op_sel:[1,1,0] op_sel_hi:[0,1,1] neg_lo:[1,0,0]
    s_mov_b32 m0, s56
    v_pk_mul_f32 v[112:113], v[58:59], v[70:71] op_sel_hi:[1,0]
    v_pk_fma_f32 v[112:113], v[58:59], v[70:71], v[112:113] op_sel:[1,1,0] op_sel_hi:[0,1,1] neg_lo:[1,0,0]
    v_cvt_pk_bf16_f32 v88, v58, -v59
    ds_write_addtid_b32 v88 offset:59744
    v_pk_mul_f32 v[114:115], v[112:113], v[70:71] op_sel_hi:[1,0]
    v_pk_fma_f32 v[114:115], v[112:113], v[70:71], v[114:115] op_sel:[1,1,0] op_sel_hi:[0,1,1] neg_lo:[1,0,0]
    v_cvt_pk_bf16_f32 v89, v112, -v113
    ds_write_addtid_b32 v89 offset:60016
    v_pk_mul_f32 v[116:117], v[114:115], v[70:71] op_sel_hi:[1,0]
    v_pk_fma_f32 v[116:117], v[114:115], v[70:71], v[116:117] op_sel:[1,1,0] op_sel_hi:[0,1,1] neg_lo:[1,0,0]
    v_cvt_pk_bf16_f32 v90, v114, -v115
    ds_write_addtid_b32 v90 offset:60288
    v_pk_mul_f32 v[118:119], v[116:117], v[70:71] op_sel_hi:[1,0]
    v_pk_fma_f32 v[118:119], v[116:117], v[70:71], v[118:119] op_sel:[1,1,0] op_sel_hi:[0,1,1] neg_lo:[1,0,0]
    v_cvt_pk_bf16_f32 v91, v116, -v117
    ds_write_addtid_b32 v91 offset:60560
    v_pk_mul_f32 v[120:121], v[118:119], v[70:71] op_sel_hi:[1,0]
    v_pk_fma_f32 v[120:121], v[118:119], v[70:71], v[120:121] op_sel:[1,1,0] op_sel_hi:[0,1,1] neg_lo:[1,0,0]
    v_cvt_pk_bf16_f32 v92, v118, -v119
    ds_write_addtid_b32 v92 offset:61920
    v_pk_mul_f32 v[122:123], v[120:121], v[70:71] op_sel_hi:[1,0]
    v_pk_fma_f32 v[122:123], v[120:121], v[70:71], v[122:123] op_sel:[1,1,0] op_sel_hi:[0,1,1] neg_lo:[1,0,0]
    v_cvt_pk_bf16_f32 v93, v120, -v121
    ds_write_addtid_b32 v93 offset:62192
    v_pk_mul_f32 v[124:125], v[122:123], v[70:71] op_sel_hi:[1,0]
    v_pk_fma_f32 v[124:125], v[122:123], v[70:71], v[124:125] op_sel:[1,1,0] op_sel_hi:[0,1,1] neg_lo:[1,0,0]
    v_cvt_pk_bf16_f32 v94, v122, -v123
    ds_write_addtid_b32 v94 offset:62464
    v_pk_mul_f32 v[126:127], v[124:125], v[70:71] op_sel_hi:[1,0]
    v_pk_fma_f32 v[126:127], v[124:125], v[70:71], v[126:127] op_sel:[1,1,0] op_sel_hi:[0,1,1] neg_lo:[1,0,0]
    v_cvt_pk_bf16_f32 v95, v124, -v125
    ds_write_addtid_b32 v95 offset:62736
    v_pk_mul_f32 v[144:145], v[58:59], v[72:73] op_sel_hi:[1,0]
    v_pk_fma_f32 v[144:145], v[58:59], v[72:73], v[144:145] op_sel:[1,1,0] op_sel_hi:[0,1,1] neg_lo:[1,0,0]
    v_cvt_pk_bf16_f32 v96, v126, -v127
    ds_write_addtid_b32 v96 offset:64096
    v_pk_mul_f32 v[146:147], v[114:115], v[72:73] op_sel_hi:[1,0]
    v_pk_fma_f32 v[146:147], v[114:115], v[72:73], v[146:147] op_sel:[1,1,0] op_sel_hi:[0,1,1] neg_lo:[1,0,0]
    v_cvt_pk_bf16_f32 v97, v144, -v145
    ds_write_addtid_b32 v97 offset:60832
    v_pk_mul_f32 v[148:149], v[118:119], v[72:73] op_sel_hi:[1,0]
    v_pk_fma_f32 v[148:149], v[118:119], v[72:73], v[148:149] op_sel:[1,1,0] op_sel_hi:[0,1,1] neg_lo:[1,0,0]
    v_cvt_pk_bf16_f32 v98, v146, -v147
    ds_write_addtid_b32 v98 offset:61376
    v_pk_mul_f32 v[150:151], v[122:123], v[72:73] op_sel_hi:[1,0]
    v_pk_fma_f32 v[150:151], v[122:123], v[72:73], v[150:151] op_sel:[1,1,0] op_sel_hi:[0,1,1] neg_lo:[1,0,0]
    v_cvt_pk_bf16_f32 v99, v148, -v149
    ds_write_addtid_b32 v99 offset:61648
    v_pk_mul_f32 v[152:153], v[126:127], v[72:73] op_sel_hi:[1,0]
    v_pk_fma_f32 v[152:153], v[126:127], v[72:73], v[152:153] op_sel:[1,1,0] op_sel_hi:[0,1,1] neg_lo:[1,0,0]
    v_cvt_pk_bf16_f32 v100, v150, -v151
    ds_write_addtid_b32 v100 offset:63552
    v_pk_mul_f32 v[154:155], v[148:149], v[72:73] op_sel_hi:[1,0]
    v_pk_fma_f32 v[154:155], v[148:149], v[72:73], v[154:155] op_sel:[1,1,0] op_sel_hi:[0,1,1] neg_lo:[1,0,0]
    v_cvt_pk_bf16_f32 v101, v152, -v153
    ds_write_addtid_b32 v101 offset:63824
    v_pk_mul_f32 v[156:157], v[152:153], v[72:73] op_sel_hi:[1,0]
    v_pk_fma_f32 v[156:157], v[152:153], v[72:73], v[156:157] op_sel:[1,1,0] op_sel_hi:[0,1,1] neg_lo:[1,0,0]
    v_cvt_pk_bf16_f32 v102, v154, -v155
    ds_write_addtid_b32 v102 offset:64640
    v_pk_mul_f32 v[158:159], v[154:155], v[72:73] op_sel_hi:[1,0]
    v_pk_fma_f32 v[158:159], v[154:155], v[72:73], v[158:159] op_sel:[1,1,0] op_sel_hi:[0,1,1] neg_lo:[1,0,0]
    v_cvt_pk_bf16_f32 v103, v156, -v157
    ds_write_addtid_b32 v103 offset:64912
    v_pk_mul_f32 v[112:113], v[156:157], v[72:73] op_sel_hi:[1,0]
    v_pk_fma_f32 v[112:113], v[156:157], v[72:73], v[112:113] op_sel:[1,1,0] op_sel_hi:[0,1,1] neg_lo:[1,0,0]
    v_cvt_pk_bf16_f32 v88, v158, -v159
    ds_write_addtid_b32 v88 offset:61104
    v_pk_mul_f32 v[114:115], v[112:113], v[72:73] op_sel_hi:[1,0]
    v_pk_fma_f32 v[114:115], v[112:113], v[72:73], v[114:115] op_sel:[1,1,0] op_sel_hi:[0,1,1] neg_lo:[1,0,0]
    v_cvt_pk_bf16_f32 v89, v112, -v113
    ds_write_addtid_b32 v89 offset:63008
    v_pk_mul_f32 v[116:117], v[114:115], v[72:73] op_sel_hi:[1,0]
    v_pk_fma_f32 v[116:117], v[114:115], v[72:73], v[116:117] op_sel:[1,1,0] op_sel_hi:[0,1,1] neg_lo:[1,0,0]
    v_cvt_pk_bf16_f32 v90, v114, -v115
    ds_write_addtid_b32 v90 offset:63280
    v_pk_mul_f32 v[118:119], v[116:117], v[72:73] op_sel_hi:[1,0]
    v_pk_fma_f32 v[118:119], v[116:117], v[72:73], v[118:119] op_sel:[1,1,0] op_sel_hi:[0,1,1] neg_lo:[1,0,0]
    v_cvt_pk_bf16_f32 v91, v116, -v117
    ds_write_addtid_b32 v91 offset:65184
    v_pk_mul_f32 v[120:121], v[118:119], v[72:73] op_sel_hi:[1,0]
    v_pk_fma_f32 v[120:121], v[118:119], v[72:73], v[120:121] op_sel:[1,1,0] op_sel_hi:[0,1,1] neg_lo:[1,0,0]
    v_cvt_pk_bf16_f32 v92, v118, -v119
    ds_write_addtid_b32 v92 offset:64368
    v_cvt_pk_bf16_f32 v93, v120, -v121
    ds_write_addtid_b32 v93 offset:65456
    s_mov_b32 m0, s36
    ds_read_b128 v[160:163], v5 offset:0
    ds_read_b128 v[192:195], v6 offset:0
    ds_read_b128 v[164:167], v5 offset:32
    ds_read_b128 v[196:199], v6 offset:32
    ds_read_b128 v[168:171], v5 offset:64
    ds_read_b128 v[200:203], v6 offset:64
    ds_read_b128 v[172:175], v5 offset:96
    ds_read_b128 v[204:207], v6 offset:96
    ds_read_b128 v[176:179], v5 offset:128
    ds_read_b128 v[208:211], v6 offset:128
    ds_read_b128 v[180:183], v5 offset:160
    ds_read_b128 v[212:215], v6 offset:160
    ds_read_b128 v[184:187], v5 offset:192
    ds_read_b128 v[216:219], v6 offset:192
    s_waitcnt lgkmcnt(12)
    v_mfma_f32_32x32x16_bf16 v[128:143], v[192:195], v[160:163], v[128:143]
    ds_read_b128 v[188:191], v5 offset:224
    ds_read_b128 v[220:223], v6 offset:224
    v_mul_f32 v81, 0x41000000, v61
    v_mul_f32 v80, 0x41000000, v60
    s_waitcnt lgkmcnt(12)
    v_mfma_f32_32x32x16_bf16 v[128:143], v[196:199], v[164:167], v[128:143]
    v_fract_f32 v81, v81
    v_exp_f32 v80, v80
    s_waitcnt lgkmcnt(10)
    v_mfma_f32_32x32x16_bf16 v[128:143], v[200:203], v[168:171], v[128:143]
    v_cos_f32 v68, v81
    v_sin_f32 v69, v81
    s_waitcnt lgkmcnt(8)
    v_mfma_f32_32x32x16_bf16 v[128:143], v[204:207], v[172:175], v[128:143]
    v_fract_f32 v83, v61
    v_mul_f32 v68, v68, v80
    s_waitcnt lgkmcnt(6)
    v_mfma_f32_32x32x16_bf16 v[128:143], v[208:211], v[176:179], v[128:143]
    v_mul_f32 v69, v69, v80
    v_exp_f32 v82, v60
    s_waitcnt lgkmcnt(4)
    v_mfma_f32_32x32x16_bf16 v[128:143], v[212:215], v[180:183], v[128:143]
    v_cos_f32 v70, v83
    v_sin_f32 v71, v83
    s_waitcnt lgkmcnt(2)
    v_mfma_f32_32x32x16_bf16 v[128:143], v[216:219], v[184:187], v[128:143]
    v_mul_f32 v70, v70, v82
    v_mul_f32 v71, v71, v82
    s_waitcnt lgkmcnt(0)
    v_mfma_f32_32x32x16_bf16 v[128:143], v[220:223], v[188:191], v[128:143]
    s_cmp_ge_u32 s3, 6
    s_cbranch_scc1 L_hi
    v_cvt_pk_bf16_f32 v89, v68, v69
    ds_write_addtid_b32 v89 offset:272
    v_pk_mul_f32 v[112:113], v[68:69], v[68:69] op_sel_hi:[1,0]
    v_pk_fma_f32 v[112:113], v[68:69], v[68:69], v[112:113] op_sel:[1,1,0] op_sel_hi:[0,1,1] neg_lo:[1,0,0]
    v_cvt_pk_bf16_f32 v90, v112, v113
    ds_write_addtid_b32 v90 offset:544
    v_pk_mul_f32 v[114:115], v[112:113], v[68:69] op_sel_hi:[1,0]
    v_pk_fma_f32 v[114:115], v[112:113], v[68:69], v[114:115] op_sel:[1,1,0] op_sel_hi:[0,1,1] neg_lo:[1,0,0]
    v_cvt_pk_bf16_f32 v91, v114, v115
    ds_write_addtid_b32 v91 offset:816
    v_pk_mul_f32 v[112:113], v[114:115], v[68:69] op_sel_hi:[1,0]
    v_pk_fma_f32 v[112:113], v[114:115], v[68:69], v[112:113] op_sel:[1,1,0] op_sel_hi:[0,1,1] neg_lo:[1,0,0]
    v_cvt_pk_bf16_f32 v92, v112, v113
    ds_write_addtid_b32 v92 offset:1088
    v_pk_mul_f32 v[114:115], v[112:113], v[68:69] op_sel_hi:[1,0]
    v_pk_fma_f32 v[114:115], v[112:113], v[68:69], v[114:115] op_sel:[1,1,0] op_sel_hi:[0,1,1] neg_lo:[1,0,0]
    v_cvt_pk_bf16_f32 v93, v114, v115
    ds_write_addtid_b32 v93 offset:1360
    v_pk_mul_f32 v[112:113], v[114:115], v[68:69] op_sel_hi:[1,0]
    v_pk_fma_f32 v[112:113], v[114:115], v[68:69], v[112:113] op_sel:[1,1,0] op_sel_hi:[0,1,1] neg_lo:[1,0,0]
    v_cvt_pk_bf16_f32 v94, v112, v113
    ds_write_addtid_b32 v94 offset:1632
    v_pk_mul_f32 v[114:115], v[112:113], v[68:69] op_sel_hi:[1,0]
    v_pk_fma_f32 v[114:115], v[112:113], v[68:69], v[114:115] op_sel:[1,1,0] op_sel_hi:[0,1,1] neg_lo:[1,0,0]
    v_cvt_pk_bf16_f32 v95, v114, v115
    ds_write_addtid_b32 v95 offset:1904
    v_pk_mul_f32 v[112:113], v[114:115], v[68:69] op_sel_hi:[1,0]
    v_pk_fma_f32 v[112:113], v[114:115], v[68:69], v[112:113] op_sel:[1,1,0] op_sel_hi:[0,1,1] neg_lo:[1,0,0]
    v_cvt_pk_bf16_f32 v96, v112, v113
    ds_write_addtid_b32 v96 offset:2176
    v_pk_mul_f32 v[114:115], v[112:113], v[68:69] op_sel_hi:[1,0]
    v_pk_fma_f32 v[114:115], v[112:113], v[68:69], v[114:115] op_sel:[1,1,0] op_sel_hi:[0,1,1] neg_lo:[1,0,0]
    v_cvt_pk_bf16_f32 v97, v114, v115
    ds_write_addtid_b32 v97 offset:2448
    v_pk_mul_f32 v[112:113], v[114:115], v[68:69] op_sel_hi:[1,0]
    v_pk_fma_f32 v[112:113], v[114:115], v[68:69], v[112:113] op_sel:[1,1,0] op_sel_hi:[0,1,1] neg_lo:[1,0,0]
    v_cvt_pk_bf16_f32 v98, v112, v113
    ds_write_addtid_b32 v98 offset:2720
    v_pk_mul_f32 v[114:115], v[112:113], v[68:69] op_sel_hi:[1,0]
    v_pk_fma_f32 v[114:115], v[112:113], v[68:69], v[114:115] op_sel:[1,1,0] op_sel_hi:[0,1,1] neg_lo:[1,0,0]
    v_cvt_pk_bf16_f32 v99, v114, v115
    ds_write_addtid_b32 v99 offset:2992
    v_pk_mul_f32 v[112:113], v[114:115], v[68:69] op_sel_hi:[1,0]
    v_pk_fma_f32 v[112:113], v[114:115], v[68:69], v[112:113] op_sel:[1,1,0] op_sel_hi:[0,1,1] neg_lo:[1,0,0]
    v_cvt_pk_bf16_f32 v100, v112, v113
    ds_write_addtid_b32 v100 offset:3264
    v_pk_mul_f32 v[114:115], v[112:113], v[68:69] op_sel_hi:[1,0]
    v_pk_fma_f32 v[114:115], v[112:113], v[68:69], v[114:115] op_sel:[1,1,0] op_sel_hi:[0,1,1] neg_lo:[1,0,0]
    v_cvt_pk_bf16_f32 v101, v114, v115
    ds_write_addtid_b32 v101 offset:3536
    v_pk_mul_f32 v[112:113], v[114:115], v[68:69] op_sel_hi:[1,0]
    v_pk_fma_f32 v[112:113], v[114:115], v[68:69], v[112:113] op_sel:[1,1,0] op_sel_hi:[0,1,1] neg_lo:[1,0,0]
    v_cvt_pk_bf16_f32 v102, v112, v113
    ds_write_addtid_b32 v102 offset:3808
    v_pk_mul_f32 v[114:115], v[112:113], v[68:69] op_sel_hi:[1,0]
    v_pk_fma_f32 v[114:115], v[112:113], v[68:69], v[114:115] op_sel:[1,1,0] op_sel_hi:[0,1,1] neg_lo:[1,0,0]
    v_cvt_pk_bf16_f32 v103, v114, v115
    ds_write_addtid_b32 v103 offset:4080
    v_pk_mul_f32 v[112:113], v[114:115], v[68:69] op_sel_hi:[1,0]
    v_pk_fma_f32 v[112:113], v[114:115], v[68:69], v[112:113] op_sel:[1,1,0] op_sel_hi:[0,1,1] neg_lo:[1,0,0]
    v_cvt_pk_bf16_f32 v88, v112, v113
    ds_write_addtid_b32 v88 offset:4352
    v_pk_mul_f32 v[114:115], v[112:113], v[68:69] op_sel_hi:[1,0]
    v_pk_fma_f32 v[114:115], v[112:113], v[68:69], v[114:115] op_sel:[1,1,0] op_sel_hi:[0,1,1] neg_lo:[1,0,0]
    v_cvt_pk_bf16_f32 v89, v114, v115
    ds_write_addtid_b32 v89 offset:4624
    v_pk_mul_f32 v[112:113], v[114:115], v[68:69] op_sel_hi:[1,0]
    v_pk_fma_f32 v[112:113], v[114:115], v[68:69], v[112:113] op_sel:[1,1,0] op_sel_hi:[0,1,1] neg_lo:[1,0,0]
    v_cvt_pk_bf16_f32 v90, v112, v113
    ds_write_addtid_b32 v90 offset:4896
    v_pk_mul_f32 v[114:115], v[112:113], v[68:69] op_sel_hi:[1,0]
    v_pk_fma_f32 v[114:115], v[112:113], v[68:69], v[114:115] op_sel:[1,1,0] op_sel_hi:[0,1,1] neg_lo:[1,0,0]
    v_cvt_pk_bf16_f32 v91, v114, v115
    ds_write_addtid_b32 v91 offset:5168
    v_pk_mul_f32 v[112:113], v[114:115], v[68:69] op_sel_hi:[1,0]
    v_pk_fma_f32 v[112:113], v[114:115], v[68:69], v[112:113] op_sel:[1,1,0] op_sel_hi:[0,1,1] neg_lo:[1,0,0]
    v_cvt_pk_bf16_f32 v92, v112, v113
    ds_write_addtid_b32 v92 offset:5440
    v_pk_mul_f32 v[114:115], v[112:113], v[68:69] op_sel_hi:[1,0]
    v_pk_fma_f32 v[114:115], v[112:113], v[68:69], v[114:115] op_sel:[1,1,0] op_sel_hi:[0,1,1] neg_lo:[1,0,0]
    v_cvt_pk_bf16_f32 v93, v114, v115
    ds_write_addtid_b32 v93 offset:5712
    v_pk_mul_f32 v[112:113], v[114:115], v[68:69] op_sel_hi:[1,0]
    v_pk_fma_f32 v[112:113], v[114:115], v[68:69], v[112:113] op_sel:[1,1,0] op_sel_hi:[0,1,1] neg_lo:[1,0,0]
    v_cvt_pk_bf16_f32 v94, v112, v113
    ds_write_addtid_b32 v94 offset:5984
    v_pk_mul_f32 v[114:115], v[112:113], v[68:69] op_sel_hi:[1,0]
    v_pk_fma_f32 v[114:115], v[112:113], v[68:69], v[114:115] op_sel:[1,1,0] op_sel_hi:[0,1,1] neg_lo:[1,0,0]
    v_cvt_pk_bf16_f32 v95, v114, v115
    ds_write_addtid_b32 v95 offset:6256
    v_pk_mul_f32 v[112:113], v[114:115], v[68:69] op_sel_hi:[1,0]
    v_pk_fma_f32 v[112:113], v[114:115], v[68:69], v[112:113] op_sel:[1,1,0] op_sel_hi:[0,1,1] neg_lo:[1,0,0]
    v_cvt_pk_bf16_f32 v96, v112, v113
    ds_write_addtid_b32 v96 offset:6528
    v_pk_mul_f32 v[114:115], v[112:113], v[68:69] op_sel_hi:[1,0]
    v_pk_fma_f32 v[114:115], v[112:113], v[68:69], v[114:115] op_sel:[1,1,0] op_sel_hi:[0,1,1] neg_lo:[1,0,0]
    v_cvt_pk_bf16_f32 v97, v114, v115
    ds_write_addtid_b32 v97 offset:6800
    v_pk_mul_f32 v[112:113], v[114:115], v[68:69] op_sel_hi:[1,0]
    v_pk_fma_f32 v[112:113], v[114:115], v[68:69], v[112:113] op_sel:[1,1,0] op_sel_hi:[0,1,1] neg_lo:[1,0,0]
    v_cvt_pk_bf16_f32 v98, v112, v113
    ds_write_addtid_b32 v98 offset:7072
    v_pk_mul_f32 v[114:115], v[112:113], v[68:69] op_sel_hi:[1,0]
    v_pk_fma_f32 v[114:115], v[112:113], v[68:69], v[114:115] op_sel:[1,1,0] op_sel_hi:[0,1,1] neg_lo:[1,0,0]
    v_cvt_pk_bf16_f32 v99, v114, v115
    ds_write_addtid_b32 v99 offset:7344
    v_pk_mul_f32 v[112:113], v[114:115], v[68:69] op_sel_hi:[1,0]
    v_pk_fma_f32 v[112:113], v[114:115], v[68:69], v[112:113] op_sel:[1,1,0] op_sel_hi:[0,1,1] neg_lo:[1,0,0]
    v_cvt_pk_bf16_f32 v100, v112, v113
    ds_write_addtid_b32 v100 offset:7616
    v_pk_mul_f32 v[114:115], v[112:113], v[68:69] op_sel_hi:[1,0]
    v_pk_fma_f32 v[114:115], v[112:113], v[68:69], v[114:115] op_sel:[1,1,0] op_sel_hi:[0,1,1] neg_lo:[1,0,0]
    v_cvt_pk_bf16_f32 v101, v114, v115
    ds_write_addtid_b32 v101 offset:7888
    v_pk_mul_f32 v[112:113], v[114:115], v[68:69] op_sel_hi:[1,0]
    v_pk_fma_f32 v[112:113], v[114:115], v[68:69], v[112:113] op_sel:[1,1,0] op_sel_hi:[0,1,1] neg_lo:[1,0,0]
    v_cvt_pk_bf16_f32 v102, v112, v113
    ds_write_addtid_b32 v102 offset:8160
    v_pk_mul_f32 v[114:115], v[112:113], v[68:69] op_sel_hi:[1,0]
    v_pk_fma_f32 v[114:115], v[112:113], v[68:69], v[114:115] op_sel:[1,1,0] op_sel_hi:[0,1,1] neg_lo:[1,0,0]
    v_cvt_pk_bf16_f32 v103, v114, v115
    ds_write_addtid_b32 v103 offset:8432
    v_pk_mul_f32 v[72:73], v[114:115], v[68:69] op_sel_hi:[1,0]
    v_pk_fma_f32 v[72:73], v[114:115], v[68:69], v[72:73] op_sel:[1,1,0] op_sel_hi:[0,1,1] neg_lo:[1,0,0]
    s_mov_b32 m0, s56
    v_pk_mul_f32 v[112:113], v[62:63], v[70:71] op_sel_hi:[1,0]
    v_pk_fma_f32 v[112:113], v[62:63], v[70:71], v[112:113] op_sel:[1,1,0] op_sel_hi:[0,1,1] neg_lo:[1,0,0]
    v_cvt_pk_bf16_f32 v88, v62, -v63
    ds_write_addtid_b32 v88 offset:59744
    v_pk_mul_f32 v[114:115], v[112:113], v[70:71] op_sel_hi:[1,0]
    v_pk_fma_f32 v[114:115], v[112:113], v[70:71], v[114:115] op_sel:[1,1,0] op_sel_hi:[0,1,1] neg_lo:[1,0,0]
    v_cvt_pk_bf16_f32 v89, v112, -v113
    ds_write_addtid_b32 v89 offset:60016
    v_pk_mul_f32 v[116:117], v[114:115], v[70:71] op_sel_hi:[1,0]
    v_pk_fma_f32 v[116:117], v[114:115], v[70:71], v[116:117] op_sel:[1,1,0] op_sel_hi:[0,1,1] neg_lo:[1,0,0]
    v_cvt_pk_bf16_f32 v90, v114, -v115
    ds_write_addtid_b32 v90 offset:60288
    v_pk_mul_f32 v[118:119], v[116:117], v[70:71] op_sel_hi:[1,0]
    v_pk_fma_f32 v[118:119], v[116:117], v[70:71], v[118:119] op_sel:[1,1,0] op_sel_hi:[0,1,1] neg_lo:[1,0,0]
    v_cvt_pk_bf16_f32 v91, v116, -v117
    ds_write_addtid_b32 v91 offset:60560
    v_pk_mul_f32 v[120:121], v[118:119], v[70:71] op_sel_hi:[1,0]
    v_pk_fma_f32 v[120:121], v[118:119], v[70:71], v[120:121] op_sel:[1,1,0] op_sel_hi:[0,1,1] neg_lo:[1,0,0]
    v_cvt_pk_bf16_f32 v92, v118, -v119
    ds_write_addtid_b32 v92 offset:61920
    v_pk_mul_f32 v[122:123], v[120:121], v[70:71] op_sel_hi:[1,0]
    v_pk_fma_f32 v[122:123], v[120:121], v[70:71], v[122:123] op_sel:[1,1,0] op_sel_hi:[0,1,1] neg_lo:[1,0,0]
    v_cvt_pk_bf16_f32 v93, v120, -v121
    ds_write_addtid_b32 v93 offset:62192
    v_pk_mul_f32 v[124:125], v[122:123], v[70:71] op_sel_hi:[1,0]
    v_pk_fma_f32 v[124:125], v[122:123], v[70:71], v[124:125] op_sel:[1,1,0] op_sel_hi:[0,1,1] neg_lo:[1,0,0]
    v_cvt_pk_bf16_f32 v94, v122, -v123
    ds_write_addtid_b32 v94 offset:62464
    v_pk_mul_f32 v[126:127], v[124:125], v[70:71] op_sel_hi:[1,0]
    v_pk_fma_f32 v[126:127], v[124:125], v[70:71], v[126:127] op_sel:[1,1,0] op_sel_hi:[0,1,1] neg_lo:[1,0,0]
    v_cvt_pk_bf16_f32 v95, v124, -v125
    ds_write_addtid_b32 v95 offset:62736
    v_pk_mul_f32 v[144:145], v[62:63], v[72:73] op_sel_hi:[1,0]
    v_pk_fma_f32 v[144:145], v[62:63], v[72:73], v[144:145] op_sel:[1,1,0] op_sel_hi:[0,1,1] neg_lo:[1,0,0]
    v_cvt_pk_bf16_f32 v96, v126, -v127
    ds_write_addtid_b32 v96 offset:64096
    v_pk_mul_f32 v[146:147], v[114:115], v[72:73] op_sel_hi:[1,0]
    v_pk_fma_f32 v[146:147], v[114:115], v[72:73], v[146:147] op_sel:[1,1,0] op_sel_hi:[0,1,1] neg_lo:[1,0,0]
    v_cvt_pk_bf16_f32 v97, v144, -v145
    ds_write_addtid_b32 v97 offset:60832
    v_pk_mul_f32 v[148:149], v[118:119], v[72:73] op_sel_hi:[1,0]
    v_pk_fma_f32 v[148:149], v[118:119], v[72:73], v[148:149] op_sel:[1,1,0] op_sel_hi:[0,1,1] neg_lo:[1,0,0]
    v_cvt_pk_bf16_f32 v98, v146, -v147
    ds_write_addtid_b32 v98 offset:61376
    v_pk_mul_f32 v[150:151], v[122:123], v[72:73] op_sel_hi:[1,0]
    v_pk_fma_f32 v[150:151], v[122:123], v[72:73], v[150:151] op_sel:[1,1,0] op_sel_hi:[0,1,1] neg_lo:[1,0,0]
    v_cvt_pk_bf16_f32 v99, v148, -v149
    ds_write_addtid_b32 v99 offset:61648
    v_pk_mul_f32 v[152:153], v[126:127], v[72:73] op_sel_hi:[1,0]
    v_pk_fma_f32 v[152:153], v[126:127], v[72:73], v[152:153] op_sel:[1,1,0] op_sel_hi:[0,1,1] neg_lo:[1,0,0]
    v_cvt_pk_bf16_f32 v100, v150, -v151
    ds_write_addtid_b32 v100 offset:63552
    v_pk_mul_f32 v[154:155], v[148:149], v[72:73] op_sel_hi:[1,0]
    v_pk_fma_f32 v[154:155], v[148:149], v[72:73], v[154:155] op_sel:[1,1,0] op_sel_hi:[0,1,1] neg_lo:[1,0,0]
    v_cvt_pk_bf16_f32 v101, v152, -v153
    ds_write_addtid_b32 v101 offset:63824
    v_pk_mul_f32 v[156:157], v[152:153], v[72:73] op_sel_hi:[1,0]
    v_pk_fma_f32 v[156:157], v[152:153], v[72:73], v[156:157] op_sel:[1,1,0] op_sel_hi:[0,1,1] neg_lo:[1,0,0]
    v_cvt_pk_bf16_f32 v102, v154, -v155
    ds_write_addtid_b32 v102 offset:64640
    v_pk_mul_f32 v[158:159], v[154:155], v[72:73] op_sel_hi:[1,0]
    v_pk_fma_f32 v[158:159], v[154:155], v[72:73], v[158:159] op_sel:[1,1,0] op_sel_hi:[0,1,1] neg_lo:[1,0,0]
    v_cvt_pk_bf16_f32 v103, v156, -v157
    ds_write_addtid_b32 v103 offset:64912
    v_pk_mul_f32 v[112:113], v[156:157], v[72:73] op_sel_hi:[1,0]
    v_pk_fma_f32 v[112:113], v[156:157], v[72:73], v[112:113] op_sel:[1,1,0] op_sel_hi:[0,1,1] neg_lo:[1,0,0]
    v_cvt_pk_bf16_f32 v88, v158, -v159
    ds_write_addtid_b32 v88 offset:61104
    v_pk_mul_f32 v[114:115], v[112:113], v[72:73] op_sel_hi:[1,0]
    v_pk_fma_f32 v[114:115], v[112:113], v[72:73], v[114:115] op_sel:[1,1,0] op_sel_hi:[0,1,1] neg_lo:[1,0,0]
    v_cvt_pk_bf16_f32 v89, v112, -v113
    ds_write_addtid_b32 v89 offset:63008
    v_pk_mul_f32 v[116:117], v[114:115], v[72:73] op_sel_hi:[1,0]
    v_pk_fma_f32 v[116:117], v[114:115], v[72:73], v[116:117] op_sel:[1,1,0] op_sel_hi:[0,1,1] neg_lo:[1,0,0]
    v_cvt_pk_bf16_f32 v90, v114, -v115
    ds_write_addtid_b32 v90 offset:63280
    v_pk_mul_f32 v[118:119], v[116:117], v[72:73] op_sel_hi:[1,0]
    v_pk_fma_f32 v[118:119], v[116:117], v[72:73], v[118:119] op_sel:[1,1,0] op_sel_hi:[0,1,1] neg_lo:[1,0,0]
    v_cvt_pk_bf16_f32 v91, v116, -v117
    ds_write_addtid_b32 v91 offset:65184
    v_pk_mul_f32 v[120:121], v[118:119], v[72:73] op_sel_hi:[1,0]
    v_pk_fma_f32 v[120:121], v[118:119], v[72:73], v[120:121] op_sel:[1,1,0] op_sel_hi:[0,1,1] neg_lo:[1,0,0]
    v_cvt_pk_bf16_f32 v92, v118, -v119
    ds_write_addtid_b32 v92 offset:64368
    v_cvt_pk_bf16_f32 v93, v120, -v121
    ds_write_addtid_b32 v93 offset:65456
    s_mov_b32 m0, s36
    ds_read_b128 v[160:163], v5 offset:0
    ds_read_b128 v[192:195], v6 offset:0
    ds_read_b128 v[164:167], v5 offset:32
    ds_read_b128 v[196:199], v6 offset:32
    ds_read_b128 v[168:171], v5 offset:64
    ds_read_b128 v[200:203], v6 offset:64
    ds_read_b128 v[172:175], v5 offset:96
    ds_read_b128 v[204:207], v6 offset:96
    ds_read_b128 v[176:179], v5 offset:128
    ds_read_b128 v[208:211], v6 offset:128
    ds_read_b128 v[180:183], v5 offset:160
    ds_read_b128 v[212:215], v6 offset:160
    ds_read_b128 v[184:187], v5 offset:192
    ds_read_b128 v[216:219], v6 offset:192
    s_waitcnt lgkmcnt(12)
    v_mfma_f32_32x32x16_bf16 v[128:143], v[192:195], v[160:163], v[128:143]
    ds_read_b128 v[188:191], v5 offset:224
    ds_read_b128 v[220:223], v6 offset:224
    v_mul_f32 v81, 0x43800000, v65
    v_mul_f32 v80, 0x43800000, v64
    s_waitcnt lgkmcnt(12)
    v_mfma_f32_32x32x16_bf16 v[128:143], v[196:199], v[164:167], v[128:143]
    v_fract_f32 v81, v81
    v_exp_f32 v80, v80
    s_waitcnt lgkmcnt(10)
    v_mfma_f32_32x32x16_bf16 v[128:143], v[200:203], v[168:171], v[128:143]
    v_cos_f32 v72, v81
    v_sin_f32 v73, v81
    s_waitcnt lgkmcnt(8)
    v_mfma_f32_32x32x16_bf16 v[128:143], v[204:207], v[172:175], v[128:143]
    v_fract_f32 v83, v65
    v_mul_f32 v72, v72, v80
    s_waitcnt lgkmcnt(6)
    v_mfma_f32_32x32x16_bf16 v[128:143], v[208:211], v[176:179], v[128:143]
    v_mul_f32 v73, v73, v80
    v_exp_f32 v82, v64
    s_waitcnt lgkmcnt(4)
    v_mfma_f32_32x32x16_bf16 v[128:143], v[212:215], v[180:183], v[128:143]
    v_cos_f32 v70, v83
    v_sin_f32 v71, v83
    s_waitcnt lgkmcnt(2)
    v_mfma_f32_32x32x16_bf16 v[128:143], v[216:219], v[184:187], v[128:143]
    v_mul_f32 v70, v70, v82
    v_mul_f32 v71, v71, v82
    s_waitcnt lgkmcnt(0)
    v_mfma_f32_32x32x16_bf16 v[128:143], v[220:223], v[188:191], v[128:143]
    v_add_u32 v5, s32, v5
    s_cmp_ge_u32 s3, 4
    s_cbranch_scc1 L_lo
    s_waitcnt vmcnt(0)
    v_perm_b32 v88, v28, v24, s38
    v_perm_b32 v89, v36, v32, s38
    ds_write_b64 v7, v[88:89] offset:0
    v_perm_b32 v90, v28, v24, s39
    v_perm_b32 v91, v36, v32, s39
    ds_write_b64 v7, v[90:91] offset:4576
    v_perm_b32 v92, v29, v25, s38
    v_perm_b32 v93, v37, v33, s38
    ds_write_b64 v7, v[92:93] offset:9152
    v_perm_b32 v94, v29, v25, s39
    v_perm_b32 v95, v37, v33, s39
    ds_write_b64 v7, v[94:95] offset:13728
    v_perm_b32 v96, v30, v26, s38
    v_perm_b32 v97, v38, v34, s38
    ds_write_b64 v7, v[96:97] offset:18304
    v_perm_b32 v98, v30, v26, s39
    v_perm_b32 v99, v38, v34, s39
    ds_write_b64 v7, v[98:99] offset:22880
    s_mov_b64 exec, 1
    ds_add_u32 v0, v74 offset:36
    s_mov_b64 exec, -1
    ds_read_b128 v[40:43], v20 offset:0
    ds_read_b128 v[44:47], v20 offset:1024
    ds_read_b128 v[48:51], v20 offset:2048
    ds_read_b128 v[52:55], v20 offset:3072
    s_mov_b32 m0, s56
    v_pk_mul_f32 v[112:113], v[66:67], v[70:71] op_sel_hi:[1,0]
    v_pk_fma_f32 v[112:113], v[66:67], v[70:71], v[112:113] op_sel:[1,1,0] op_sel_hi:[0,1,1] neg_lo:[1,0,0]
    v_cvt_pk_bf16_f32 v88, v66, -v67
    ds_write_addtid_b32 v88 offset:59744
    v_pk_mul_f32 v[114:115], v[112:113], v[70:71] op_sel_hi:[1,0]
    v_pk_fma_f32 v[114:115], v[112:113], v[70:71], v[114:115] op_sel:[1,1,0] op_sel_hi:[0,1,1] neg_lo:[1,0,0]
    v_cvt_pk_bf16_f32 v89, v112, -v113
    ds_write_addtid_b32 v89 offset:60016
    v_pk_mul_f32 v[116:117], v[114:115], v[70:71] op_sel_hi:[1,0]
    v_pk_fma_f32 v[116:117], v[114:115], v[70:71], v[116:117] op_sel:[1,1,0] op_sel_hi:[0,1,1] neg_lo:[1,0,0]
    v_cvt_pk_bf16_f32 v90, v114, -v115
    ds_write_addtid_b32 v90 offset:60288
    v_pk_mul_f32 v[118:119], v[116:117], v[70:71] op_sel_hi:[1,0]
    v_pk_fma_f32 v[118:119], v[116:117], v[70:71], v[118:119] op_sel:[1,1,0] op_sel_hi:[0,1,1] neg_lo:[1,0,0]
    v_cvt_pk_bf16_f32 v91, v116, -v117
    ds_write_addtid_b32 v91 offset:60560
    v_pk_mul_f32 v[120:121], v[118:119], v[70:71] op_sel_hi:[1,0]
    v_pk_fma_f32 v[120:121], v[118:119], v[70:71], v[120:121] op_sel:[1,1,0] op_sel_hi:[0,1,1] neg_lo:[1,0,0]
    v_cvt_pk_bf16_f32 v92, v118, -v119
    ds_write_addtid_b32 v92 offset:61920
    v_pk_mul_f32 v[122:123], v[120:121], v[70:71] op_sel_hi:[1,0]
    v_pk_fma_f32 v[122:123], v[120:121], v[70:71], v[122:123] op_sel:[1,1,0] op_sel_hi:[0,1,1] neg_lo:[1,0,0]
    v_cvt_pk_bf16_f32 v93, v120, -v121
    ds_write_addtid_b32 v93 offset:62192
    v_pk_mul_f32 v[124:125], v[122:123], v[70:71] op_sel_hi:[1,0]
    v_pk_fma_f32 v[124:125], v[122:123], v[70:71], v[124:125] op_sel:[1,1,0] op_sel_hi:[0,1,1] neg_lo:[1,0,0]
    v_cvt_pk_bf16_f32 v94, v122, -v123
    ds_write_addtid_b32 v94 offset:62464
    v_pk_mul_f32 v[126:127], v[124:125], v[70:71] op_sel_hi:[1,0]
    v_pk_fma_f32 v[126:127], v[124:125], v[70:71], v[126:127] op_sel:[1,1,0] op_sel_hi:[0,1,1] neg_lo:[1,0,0]
    v_cvt_pk_bf16_f32 v95, v124, -v125
    ds_write_addtid_b32 v95 offset:62736
    v_pk_mul_f32 v[144:145], v[66:67], v[72:73] op_sel_hi:[1,0]
    v_pk_fma_f32 v[144:145], v[66:67], v[72:73], v[144:145] op_sel:[1,1,0] op_sel_hi:[0,1,1] neg_lo:[1,0,0]
    v_cvt_pk_bf16_f32 v96, v126, -v127
    ds_write_addtid_b32 v96 offset:64096
    v_pk_mul_f32 v[146:147], v[114:115], v[72:73] op_sel_hi:[1,0]
    v_pk_fma_f32 v[146:147], v[114:115], v[72:73], v[146:147] op_sel:[1,1,0] op_sel_hi:[0,1,1] neg_lo:[1,0,0]
    v_cvt_pk_bf16_f32 v97, v144, -v145
    ds_write_addtid_b32 v97 offset:60832
    v_pk_mul_f32 v[148:149], v[118:119], v[72:73] op_sel_hi:[1,0]
    v_pk_fma_f32 v[148:149], v[118:119], v[72:73], v[148:149] op_sel:[1,1,0] op_sel_hi:[0,1,1] neg_lo:[1,0,0]
    v_cvt_pk_bf16_f32 v98, v146, -v147
    ds_write_addtid_b32 v98 offset:61376
    v_pk_mul_f32 v[150:151], v[122:123], v[72:73] op_sel_hi:[1,0]
    v_pk_fma_f32 v[150:151], v[122:123], v[72:73], v[150:151] op_sel:[1,1,0] op_sel_hi:[0,1,1] neg_lo:[1,0,0]
    v_cvt_pk_bf16_f32 v99, v148, -v149
    ds_write_addtid_b32 v99 offset:61648
    v_pk_mul_f32 v[152:153], v[126:127], v[72:73] op_sel_hi:[1,0]
    v_pk_fma_f32 v[152:153], v[126:127], v[72:73], v[152:153] op_sel:[1,1,0] op_sel_hi:[0,1,1] neg_lo:[1,0,0]
    v_cvt_pk_bf16_f32 v100, v150, -v151
    ds_write_addtid_b32 v100 offset:63552
    v_pk_mul_f32 v[154:155], v[148:149], v[72:73] op_sel_hi:[1,0]
    v_pk_fma_f32 v[154:155], v[148:149], v[72:73], v[154:155] op_sel:[1,1,0] op_sel_hi:[0,1,1] neg_lo:[1,0,0]
    v_cvt_pk_bf16_f32 v101, v152, -v153
    ds_write_addtid_b32 v101 offset:63824
    v_pk_mul_f32 v[156:157], v[152:153], v[72:73] op_sel_hi:[1,0]
    v_pk_fma_f32 v[156:157], v[152:153], v[72:73], v[156:157] op_sel:[1,1,0] op_sel_hi:[0,1,1] neg_lo:[1,0,0]
    v_cvt_pk_bf16_f32 v102, v154, -v155
    ds_write_addtid_b32 v102 offset:64640
    v_pk_mul_f32 v[158:159], v[154:155], v[72:73] op_sel_hi:[1,0]
    v_pk_fma_f32 v[158:159], v[154:155], v[72:73], v[158:159] op_sel:[1,1,0] op_sel_hi:[0,1,1] neg_lo:[1,0,0]
    v_cvt_pk_bf16_f32 v103, v156, -v157
    ds_write_addtid_b32 v103 offset:64912
    v_pk_mul_f32 v[112:113], v[156:157], v[72:73] op_sel_hi:[1,0]
    v_pk_fma_f32 v[112:113], v[156:157], v[72:73], v[112:113] op_sel:[1,1,0] op_sel_hi:[0,1,1] neg_lo:[1,0,0]
    v_cvt_pk_bf16_f32 v88, v158, -v159
    ds_write_addtid_b32 v88 offset:61104
    v_pk_mul_f32 v[114:115], v[112:113], v[72:73] op_sel_hi:[1,0]
    v_pk_fma_f32 v[114:115], v[112:113], v[72:73], v[114:115] op_sel:[1,1,0] op_sel_hi:[0,1,1] neg_lo:[1,0,0]
    v_cvt_pk_bf16_f32 v89, v112, -v113
    ds_write_addtid_b32 v89 offset:63008
    v_pk_mul_f32 v[116:117], v[114:115], v[72:73] op_sel_hi:[1,0]
    v_pk_fma_f32 v[116:117], v[114:115], v[72:73], v[116:117] op_sel:[1,1,0] op_sel_hi:[0,1,1] neg_lo:[1,0,0]
    v_cvt_pk_bf16_f32 v90, v114, -v115
    ds_write_addtid_b32 v90 offset:63280
    v_pk_mul_f32 v[118:119], v[116:117], v[72:73] op_sel_hi:[1,0]
    v_pk_fma_f32 v[118:119], v[116:117], v[72:73], v[118:119] op_sel:[1,1,0] op_sel_hi:[0,1,1] neg_lo:[1,0,0]
    v_cvt_pk_bf16_f32 v91, v116, -v117
    ds_write_addtid_b32 v91 offset:65184
    v_pk_mul_f32 v[120:121], v[118:119], v[72:73] op_sel_hi:[1,0]
    v_pk_fma_f32 v[120:121], v[118:119], v[72:73], v[120:121] op_sel:[1,1,0] op_sel_hi:[0,1,1] neg_lo:[1,0,0]
    v_cvt_pk_bf16_f32 v92, v118, -v119
    ds_write_addtid_b32 v92 offset:64368
    v_cvt_pk_bf16_f32 v93, v120, -v121
    ds_write_addtid_b32 v93 offset:65456
    s_mov_b32 m0, s36
    s_setprio 3
    s_mov_b64 exec, 1
    ds_add_u32 v0, v74 offset:56
    s_mov_b64 exec, -1
    ds_read_b32 v1, v0 offset:36
    ds_read_b32 v23, v75 offset:64
    s_waitcnt lgkmcnt(0)
L_cxv:
    v_readfirstlane_b32 s42, v23
    s_nop 0
    s_cmp_eq_u32 s42, 1
    s_cbranch_scc1 L_rxv
    ds_read_b32 v23, v75 offset:64
    s_waitcnt lgkmcnt(0)
    s_branch L_cxv
L_rxv:
    ds_read_b128 v[160:163], v5 offset:0
    ds_read_b128 v[192:195], v6 offset:0
    ds_read_b128 v[164:167], v5 offset:32
    ds_read_b128 v[196:199], v6 offset:32
    ds_read_b128 v[168:171], v5 offset:64
    ds_read_b128 v[200:203], v6 offset:64
    ds_read_b128 v[172:175], v5 offset:96
    ds_read_b128 v[204:207], v6 offset:96
    ds_read_b128 v[176:179], v5 offset:128
    ds_read_b128 v[208:211], v6 offset:128
    ds_read_b128 v[180:183], v5 offset:160
    ds_read_b128 v[212:215], v6 offset:160
    ds_read_b128 v[184:187], v5 offset:192
    ds_read_b128 v[216:219], v6 offset:192
L_cxa:
    v_readfirstlane_b32 s43, v1
    s_nop 0
    s_cmp_eq_u32 s43, 4
    s_cbranch_scc1 L_rxa
    ds_read_b32 v1, v0 offset:36
    s_waitcnt lgkmcnt(0)
    s_branch L_cxa
L_rxa:
    s_waitcnt lgkmcnt(12)
    v_mfma_f32_32x32x16_bf16 v[128:143], v[192:195], v[160:163], v[128:143]
    ds_read_b128 v[188:191], v5 offset:224
    ds_read_b128 v[220:223], v6 offset:224
    v_mov_b32 v76, 0
    v_mov_b32 v77, 0
    s_waitcnt lgkmcnt(12)
    v_mfma_f32_32x32x16_bf16 v[128:143], v[196:199], v[164:167], v[128:143]
    v_mov_b32 v78, 0
    v_mov_b32 v79, 0
    s_waitcnt lgkmcnt(10)
    v_mfma_f32_32x32x16_bf16 v[128:143], v[200:203], v[168:171], v[128:143]
    ds_write_b128 v22, v[76:79] offset:256
    ds_read_b128 v[56:59], v11 offset:448
    s_waitcnt lgkmcnt(10)
    v_mfma_f32_32x32x16_bf16 v[128:143], v[204:207], v[172:175], v[128:143]
    ds_read_b128 v[60:63], v11 offset:432
    ds_read_b128 v[64:67], v11 offset:960
    s_waitcnt lgkmcnt(10)
    v_mfma_f32_32x32x16_bf16 v[128:143], v[208:211], v[176:179], v[128:143]
    ds_read_b128 v[68:71], v11 offset:944
    ds_read_b128 v[144:147], v11 offset:0
    s_waitcnt lgkmcnt(10)
    v_mfma_f32_32x32x16_bf16 v[128:143], v[212:215], v[180:183], v[128:143]
    ds_read_b128 v[148:151], v11 offset:64
    ds_read_b128 v[152:155], v11 offset:128
    s_waitcnt lgkmcnt(10)
    v_mfma_f32_32x32x16_bf16 v[128:143], v[216:219], v[184:187], v[128:143]
    ds_read_b128 v[156:159], v11 offset:192
    s_waitcnt lgkmcnt(9)
    v_mfma_f32_32x32x16_bf16 v[128:143], v[220:223], v[188:191], v[128:143]
    s_nop 11
    v_add_f32 v128, v128, v21
    v_cvt_pk_bf16_f32 v184, v135, v134
    v_cvt_pk_bf16_f32 v185, v133, v132
    v_cvt_pk_bf16_f32 v186, v131, v130
    v_cvt_pk_bf16_f32 v187, v129, v128
    ds_write_b128 v8, v[184:187] offset:16
    v_cvt_pk_bf16_f32 v188, v136, v135
    v_cvt_pk_bf16_f32 v189, v134, v133
    v_cvt_pk_bf16_f32 v190, v132, v131
    v_cvt_pk_bf16_f32 v191, v130, v129
    ds_write_b128 v8, v[188:191] offset:1104
    v_and_b32 v184, 0xffff0000, v188
    v_mov_b32 v185, v188
    s_mov_b32 exec_lo, 0
    s_mov_b32 exec_hi, 0x80000000
    ds_write_b64 v8, v[184:185] offset:8
    ds_write_b32 v8, v188 offset:1100
    s_mov_b64 exec, 1
    ds_write_b16_d16_hi v8, v187 offset:1120
    s_mov_b64 exec, -1
    ds_read2_b32 v[212:213], v17 offset0:128 offset1:129
    ds_read2_b32 v[214:215], v17 offset0:130 offset1:131
    s_waitcnt lgkmcnt(13)
    v_mfma_f32_16x16x32_bf16 v[104:107], v[56:59], v[48:51], 0
    v_cvt_pk_bf16_f32 v189, v139, v138
    v_cvt_pk_bf16_f32 v190, v140, v141
    v_mfma_f32_16x16x32_bf16 v[108:111], v[56:59], v[52:55], 0
    ds_write_b32 v10, v189
    ds_write_b16 v9, v190 offset:64
    v_mfma_f32_16x16x32_bf16 v[76:79], v[56:59], v[44:47], 0
    ds_read_b128 v[56:59], v11 offset:256
    ds_write_b16_d16_hi v9, v190
    ds_read2_b32 v[244:245], v17 offset0:0 offset1:1
    ds_read2_b32 v[246:247], v17 offset0:2 offset1:3
    v_mfma_f32_16x16x32_bf16 v[4:7], v[60:63], v[48:51], 0
    v_mov_b32 v2, s40
    ds_read_b128 v[252:255], v20 offset:4096
    v_mfma_f32_16x16x32_bf16 v[100:103], v[60:63], v[52:55], 0
    ds_read_u16 v2, v2 offset:2592
    v_cvt_pk_bf16_f32 v113, v104, v108
    v_mfma_f32_16x16x32_bf16 v[92:95], v[60:63], v[40:43], 0
    ds_read_b128 v[60:63], v11 offset:320
    ds_read2_b32 v[208:209], v17 offset0:144 offset1:145
    ds_read2_b32 v[210:211], v17 offset0:146 offset1:147
    s_waitcnt lgkmcnt(14)
    v_cvt_pk_bf16_f32 v115, v105, v109
    v_cvt_pk_bf16_f32 v117, v106, v110
    v_cvt_pk_bf16_f32 v119, v107, v111
    v_mfma_f32_16x16x32_bf16 v[104:107], v[64:67], v[48:51], 0
    v_cvt_pk_bf16_f32 v112, v4, v100
    v_cvt_pk_bf16_f32 v114, v5, v101
    v_mfma_f32_16x16x32_bf16 v[108:111], v[64:67], v[52:55], 0
    v_cvt_pk_bf16_f32 v116, v6, v102
    v_cvt_pk_bf16_f32 v118, v7, v103
    v_mfma_f32_16x16x32_bf16 v[4:7], v[64:67], v[44:47], 0
    ds_read_b128 v[64:67], v11 offset:384
    v_cvt_pk_bf16_f32 v24, v92, v76
    ds_read2_b32 v[240:241], v17 offset0:16 offset1:17
    ds_read2_b32 v[242:243], v17 offset0:18 offset1:19
    v_cvt_pk_bf16_f32 v25, v93, v77
    v_cvt_pk_bf16_f32 v26, v94, v78
    v_cvt_pk_bf16_f32 v27, v95, v79
    v_mfma_f32_16x16x32_bf16 v[100:103], v[68:71], v[48:51], 0
    v_cvt_pk_bf16_f32 v121, v104, v108
    v_cvt_pk_bf16_f32 v123, v105, v109
    v_mfma_f32_16x16x32_bf16 v[92:95], v[68:71], v[52:55], 0
    v_cvt_pk_bf16_f32 v125, v106, v110
    v_cvt_pk_bf16_f32 v127, v107, v111
    v_mfma_f32_16x16x32_bf16 v[76:79], v[68:71], v[40:43], 0
    ds_read_b128 v[68:71], v11 offset:448
    ds_read2_b32 v[204:205], v17 offset0:160 offset1:161
    ds_read2_b32 v[206:207], v17 offset0:162 offset1:163
    ds_read2_b32 v[236:237], v17 offset0:32 offset1:33
    ds_read2_b32 v[238:239], v17 offset0:34 offset1:35
    s_waitcnt lgkmcnt(14)
    s_waitcnt lgkmcnt(14)
    v_mfma_f32_16x16x32_bf16 v[80:83], v[212:215], v[144:147], 0
    v_cvt_pk_bf16_f32 v120, v100, v92
    v_cvt_pk_bf16_f32 v122, v101, v93
    s_waitcnt lgkmcnt(13)
    v_mfma_f32_16x16x32_bf16 v[84:87], v[244:247], v[144:147], 0
    ds_read_b128 v[144:147], v11 offset:512
    v_cvt_pk_bf16_f32 v124, v102, v94
    ds_read2_b32 v[200:201], v17 offset0:176 offset1:177
    ds_read2_b32 v[202:203], v17 offset0:178 offset1:179
    ds_read2_b32 v[232:233], v17 offset0:48 offset1:49
    ds_read2_b32 v[234:235], v17 offset0:50 offset1:51
    s_waitcnt lgkmcnt(13)
    v_mfma_f32_16x16x32_bf16 v[80:83], v[208:211], v[148:151], v[80:83]
    v_cvt_pk_bf16_f32 v126, v103, v95
    v_cvt_pk_bf16_f32 v28, v76, v4
    s_waitcnt lgkmcnt(10)
    v_mfma_f32_16x16x32_bf16 v[84:87], v[240:243], v[148:151], v[84:87]
    ds_read_b128 v[148:151], v11 offset:576
    v_cvt_pk_bf16_f32 v29, v77, v5
    ds_read2_b32 v[196:197], v17 offset0:192 offset1:193
    ds_read2_b32 v[198:199], v17 offset0:194 offset1:195
    ds_read2_b32 v[228:229], v17 offset0:64 offset1:65
    ds_read2_b32 v[230:231], v17 offset0:66 offset1:67
    s_waitcnt lgkmcnt(12)
    v_mfma_f32_16x16x32_bf16 v[80:83], v[204:207], v[152:155], v[80:83]
    v_cvt_pk_bf16_f32 v30, v78, v6
    v_cvt_pk_bf16_f32 v31, v79, v7
    s_waitcnt lgkmcnt(10)
    v_mfma_f32_16x16x32_bf16 v[84:87], v[236:239], v[152:155], v[84:87]
    ds_read_b128 v[152:155], v11 offset:640
    ds_read2_b32 v[192:193], v17 offset0:208 offset1:209
    ds_read2_b32 v[194:195], v17 offset0:210 offset1:211
    ds_read2_b32 v[224:225], v17 offset0:80 offset1:81
    ds_read2_b32 v[226:227], v17 offset0:82 offset1:83
    s_waitcnt lgkmcnt(12)
    v_mfma_f32_16x16x32_bf16 v[80:83], v[200:203], v[156:159], v[80:83]
    s_waitcnt lgkmcnt(10)
    v_mfma_f32_16x16x32_bf16 v[84:87], v[232:235], v[156:159], v[84:87]
    ds_read_b128 v[156:159], v11 offset:704
    ds_read2_b32 v[188:189], v17 offset0:224 offset1:225
    ds_read2_b32 v[190:191], v17 offset0:226 offset1:227
    ds_read2_b32 v[220:221], v17 offset0:96 offset1:97
    ds_read2_b32 v[222:223], v17 offset0:98 offset1:99
    s_waitcnt lgkmcnt(12)
    v_mfma_f32_16x16x32_bf16 v[80:83], v[196:199], v[56:59], v[80:83]
    v_lshl_or_b32 v2, v2, 16, v2
    v_and_b32 v252, v2, v252
    s_waitcnt lgkmcnt(10)
    v_mfma_f32_16x16x32_bf16 v[84:87], v[228:231], v[56:59], v[84:87]
    ds_read_b128 v[56:59], v11 offset:768
    v_and_b32 v253, v2, v253
    ds_read2_b32 v[184:185], v17 offset0:240 offset1:241
    ds_read2_b32 v[186:187], v17 offset0:242 offset1:243
    ds_read2_b32 v[216:217], v17 offset0:112 offset1:113
    ds_read2_b32 v[218:219], v17 offset0:114 offset1:115
    ds_read2_b32 v[248:249], v16 offset0:0 offset1:1
    ds_read2_b32 v[250:251], v16 offset0:2 offset1:3
    s_waitcnt lgkmcnt(14)
    v_mfma_f32_16x16x32_bf16 v[80:83], v[192:195], v[60:63], v[80:83]
    v_and_b32 v254, v2, v254
    v_and_b32 v255, v2, v255
    s_waitcnt lgkmcnt(12)
    v_mfma_f32_16x16x32_bf16 v[84:87], v[224:227], v[60:63], v[84:87]
    ds_read_b128 v[60:63], v11 offset:832
    s_waitcnt lgkmcnt(10)
    v_mfma_f32_16x16x32_bf16 v[80:83], v[188:191], v[64:67], v[80:83]
    s_waitcnt lgkmcnt(8)
    v_mfma_f32_16x16x32_bf16 v[84:87], v[220:223], v[64:67], v[84:87]
    ds_read_b128 v[64:67], v11 offset:896
    s_waitcnt lgkmcnt(6)
    v_mfma_f32_16x16x32_bf16 v[80:83], v[184:187], v[68:71], v[80:83]
    s_waitcnt lgkmcnt(4)
    v_mfma_f32_16x16x32_bf16 v[84:87], v[216:219], v[68:71], v[84:87]
    s_waitcnt lgkmcnt(2)
    v_mfma_f32_16x16x32_bf16 v[88:91], v[248:251], v[68:71], 0
    v_mfma_f32_16x16x32_bf16 v[96:99], v[252:255], v[68:71], 0
    ds_read_b128 v[68:71], v11 offset:960
    v_mfma_f32_16x16x32_bf16 v[84:87], v[212:215], v[144:147], v[84:87]
    v_mfma_f32_16x16x32_bf16 v[88:91], v[244:247], v[144:147], v[88:91]
    v_cvt_pk_bf16_f32 v22, v80, v81
    v_cvt_pk_bf16_f32 v23, v82, v83
    v_mfma_f32_16x16x32_bf16 v[84:87], v[208:211], v[148:151], v[84:87]
    ds_write_b64 v13, v[22:23] offset:0
    s_mov_b64 exec, 1
    ds_add_u32 v0, v74 offset:0
    s_mov_b64 exec, -1
    s_setprio 2
    v_mfma_f32_16x16x32_bf16 v[88:91], v[240:243], v[148:151], v[88:91]
    ds_read_b128 v[144:147], v11 offset:1024
    ds_read_b128 v[148:151], v11 offset:1088
    v_mfma_f32_16x16x32_bf16 v[84:87], v[204:207], v[152:155], v[84:87]
    v_mfma_f32_16x16x32_bf16 v[88:91], v[236:239], v[152:155], v[88:91]
    ds_read_b128 v[152:155], v11 offset:1152
    v_mfma_f32_16x16x32_bf16 v[84:87], v[200:203], v[156:159], v[84:87]
    ds_read_b64 v[160:161], v19 offset:256
    ds_read_b64 v[162:163], v19 offset:264
    v_mfma_f32_16x16x32_bf16 v[88:91], v[232:235], v[156:159], v[88:91]
    ds_read_b128 v[156:159], v11 offset:1216
    v_mfma_f32_16x16x32_bf16 v[84:87], v[196:199], v[56:59], v[84:87]
    v_mfma_f32_16x16x32_bf16 v[88:91], v[228:231], v[56:59], v[88:91]
    ds_read_b128 v[56:59], v11 offset:1280
    s_waitcnt lgkmcnt(10)
    v_mfma_f32_16x16x32_bf16 v[84:87], v[192:195], v[60:63], v[84:87]
    v_mfma_f32_16x16x32_bf16 v[88:91], v[224:227], v[60:63], v[88:91]
    ds_read_b128 v[60:63], v11 offset:1344
    v_mfma_f32_16x16x32_bf16 v[84:87], v[188:191], v[64:67], v[84:87]
    v_mfma_f32_16x16x32_bf16 v[88:91], v[220:223], v[64:67], v[88:91]
    ds_read_b128 v[64:67], v11 offset:1408
    s_waitcnt lgkmcnt(8)
    v_mfma_f32_16x16x32_bf16 v[84:87], v[184:187], v[68:71], v[84:87]
    ds_read_b64 v[164:165], v19 offset:272
    ds_read_b64 v[166:167], v19 offset:280
    v_mfma_f32_16x16x32_bf16 v[88:91], v[216:219], v[68:71], v[88:91]
    v_mfma_f32_16x16x32_bf16 v[92:95], v[248:251], v[68:71], 0
    v_mfma_f32_16x16x32_bf16 v[100:103], v[252:255], v[68:71], 0
    ds_read_b128 v[68:71], v11 offset:1472
    s_waitcnt lgkmcnt(7)
    v_mfma_f32_16x16x32_bf16 v[88:91], v[112:115], v[160:163], v[88:91]
    v_cvt_pk_bf16_f32 v22, v84, v85
    v_cvt_pk_bf16_f32 v23, v86, v87
    v_mfma_f32_16x16x32_bf16 v[88:91], v[212:215], v[144:147], v[88:91]
    ds_write_b64 v13, v[22:23] offset:640
    s_mov_b64 exec, 1
    ds_add_u32 v0, v74 offset:4
    s_mov_b64 exec, -1
    v_mfma_f32_16x16x32_bf16 v[92:95], v[244:247], v[144:147], v[92:95]
    ds_read_b128 v[144:147], v11 offset:1536
    v_mfma_f32_16x16x32_bf16 v[88:91], v[208:211], v[148:151], v[88:91]
    v_mfma_f32_16x16x32_bf16 v[92:95], v[240:243], v[148:151], v[92:95]
    ds_read_b128 v[148:151], v11 offset:1600
    v_mfma_f32_16x16x32_bf16 v[88:91], v[204:207], v[152:155], v[88:91]
    v_mfma_f32_16x16x32_bf16 v[92:95], v[236:239], v[152:155], v[92:95]
    ds_read_b128 v[152:155], v11 offset:1664
    s_waitcnt lgkmcnt(10)
    v_mfma_f32_16x16x32_bf16 v[88:91], v[200:203], v[156:159], v[88:91]
    ds_read_b64 v[168:169], v19 offset:128
    ds_read_b64 v[170:171], v19 offset:136
    v_mfma_f32_16x16x32_bf16 v[92:95], v[232:235], v[156:159], v[92:95]
    ds_read_b128 v[156:159], v11 offset:1456
    s_waitcnt lgkmcnt(9)
    v_mfma_f32_16x16x32_bf16 v[88:91], v[116:119], v[164:167], v[88:91]
    v_mfma_f32_16x16x32_bf16 v[88:91], v[196:199], v[56:59], v[88:91]
    v_mfma_f32_16x16x32_bf16 v[92:95], v[228:231], v[56:59], v[92:95]
    ds_read_b128 v[56:59], v11 offset:1728
    v_mfma_f32_16x16x32_bf16 v[88:91], v[192:195], v[60:63], v[88:91]
    ds_read_b64 v[172:173], v19 offset:144
    ds_read_b64 v[174:175], v19 offset:152
    v_mfma_f32_16x16x32_bf16 v[92:95], v[224:227], v[60:63], v[92:95]
    ds_read_b32 v1, v0 offset:32
    ds_read_b128 v[60:63], v11 offset:1792
    v_mfma_f32_16x16x32_bf16 v[88:91], v[188:191], v[64:67], v[88:91]
    v_mfma_f32_16x16x32_bf16 v[92:95], v[220:223], v[64:67], v[92:95]
    ds_read_b128 v[64:67], v11 offset:1856
    s_waitcnt lgkmcnt(11)
    v_mfma_f32_16x16x32_bf16 v[88:91], v[184:187], v[68:71], v[88:91]
    v_mfma_f32_16x16x32_bf16 v[92:95], v[216:219], v[68:71], v[92:95]
    v_mfma_f32_16x16x32_bf16 v[96:99], v[248:251], v[68:71], v[96:99]
    v_mfma_f32_16x16x32_bf16 v[104:107], v[252:255], v[68:71], 0
    v_mfma_f32_16x16x32_bf16 v[84:87], v[68:71], v[48:51], 0
    v_mfma_f32_16x16x32_bf16 v[80:83], v[68:71], v[52:55], 0
    v_mfma_f32_16x16x32_bf16 v[76:79], v[68:71], v[44:47], 0
    ds_read_b128 v[68:71], v11 offset:1920
    s_waitcnt lgkmcnt(8)
    v_mfma_f32_16x16x32_bf16 v[92:95], v[112:115], v[168:171], v[92:95]
    v_cvt_pk_bf16_f32 v22, v88, v89
    v_cvt_pk_bf16_f32 v23, v90, v91
    v_mfma_f32_16x16x32_bf16 v[92:95], v[212:215], v[144:147], v[92:95]
    ds_write_b64 v13, v[22:23] offset:1280
    s_mov_b64 exec, 1
    ds_add_u32 v0, v74 offset:8
    s_mov_b64 exec, -1
    s_setprio 1
    v_mfma_f32_16x16x32_bf16 v[96:99], v[244:247], v[144:147], v[96:99]
    ds_read_b128 v[144:147], v11 offset:1984
    v_cvt_pk_bf16_f32 v129, v84, v80
    v_mfma_f32_16x16x32_bf16 v[92:95], v[208:211], v[148:151], v[92:95]
    v_cvt_pk_bf16_f32 v131, v85, v81
    v_cvt_pk_bf16_f32 v133, v86, v82
    v_mfma_f32_16x16x32_bf16 v[96:99], v[240:243], v[148:151], v[96:99]
    v_cvt_pk_bf16_f32 v135, v87, v83
    s_waitcnt lgkmcnt(7)
    v_mfma_f32_16x16x32_bf16 v[92:95], v[116:119], v[172:175], v[92:95]
    v_mfma_f32_16x16x32_bf16 v[92:95], v[204:207], v[152:155], v[92:95]
    v_mfma_f32_16x16x32_bf16 v[96:99], v[236:239], v[152:155], v[96:99]
    v_mfma_f32_16x16x32_bf16 v[88:91], v[156:159], v[48:51], 0
    v_mfma_f32_16x16x32_bf16 v[108:111], v[156:159], v[52:55], 0
    v_mfma_f32_16x16x32_bf16 v[4:7], v[156:159], v[40:43], 0
    v_mfma_f32_16x16x32_bf16 v[92:95], v[200:203], v[56:59], v[92:95]
    ds_read_b64 v[176:177], v19 offset:0
    ds_read_b64 v[178:179], v19 offset:8
    v_mfma_f32_16x16x32_bf16 v[96:99], v[232:235], v[56:59], v[96:99]
    s_waitcnt lgkmcnt(6)
    v_mfma_f32_16x16x32_bf16 v[92:95], v[120:123], v[160:163], v[92:95]
    ds_read_b64 v[180:181], v19 offset:16
    ds_read_b64 v[182:183], v19 offset:24
    v_mfma_f32_16x16x32_bf16 v[92:95], v[196:199], v[60:63], v[92:95]
    v_cvt_pk_bf16_f32 v128, v88, v108
    v_cvt_pk_bf16_f32 v130, v89, v109
    v_mfma_f32_16x16x32_bf16 v[96:99], v[228:231], v[60:63], v[96:99]
L_cxh:
    v_readfirstlane_b32 s43, v1
    s_nop 0
    s_cmp_eq_u32 s43, 2
    s_cbranch_scc1 L_rxh
    ds_read_b32 v1, v0 offset:32
    s_waitcnt lgkmcnt(0)
    s_branch L_cxh
L_rxh:
    ds_read_b128 v[148:151], v11 offset:2048
    v_mfma_f32_16x16x32_bf16 v[92:95], v[192:195], v[64:67], v[92:95]
    ds_read_b128 v[152:155], v11 offset:2112
    ds_read_b128 v[156:159], v11 offset:2176
    v_mfma_f32_16x16x32_bf16 v[96:99], v[224:227], v[64:67], v[96:99]
    ds_read_b128 v[56:59], v11 offset:1968
    s_waitcnt lgkmcnt(8)
    v_mfma_f32_16x16x32_bf16 v[92:95], v[124:127], v[164:167], v[92:95]
    ds_read_b128 v[60:63], v11 offset:2240
    ds_read_b128 v[64:67], v11 offset:2304
    v_mfma_f32_16x16x32_bf16 v[92:95], v[188:191], v[68:71], v[92:95]
    v_cvt_pk_bf16_f32 v132, v90, v110
    v_cvt_pk_bf16_f32 v134, v91, v111
    v_mfma_f32_16x16x32_bf16 v[96:99], v[220:223], v[68:71], v[96:99]
    ds_read_b128 v[68:71], v11 offset:2368
    v_cvt_pk_bf16_f32 v32, v4, v76
    v_mfma_f32_16x16x32_bf16 v[92:95], v[184:187], v[144:147], v[92:95]
    v_cvt_pk_bf16_f32 v33, v5, v77
    v_cvt_pk_bf16_f32 v34, v6, v78
    v_mfma_f32_16x16x32_bf16 v[96:99], v[216:219], v[144:147], v[96:99]
    v_cvt_pk_bf16_f32 v35, v7, v79
    v_mfma_f32_16x16x32_bf16 v[100:103], v[248:251], v[144:147], v[100:103]
    v_mfma_f32_16x16x32_bf16 v[108:111], v[252:255], v[144:147], 0
    v_mfma_f32_16x16x32_bf16 v[84:87], v[144:147], v[48:51], 0
    v_mfma_f32_16x16x32_bf16 v[80:83], v[144:147], v[52:55], 0
    v_cvt_pk_bf16_f32 v22, v92, v93
    v_cvt_pk_bf16_f32 v23, v94, v95
    v_mfma_f32_16x16x32_bf16 v[88:91], v[144:147], v[44:47], 0
    ds_write_b64 v13, v[22:23] offset:1920
    s_waitcnt lgkmcnt(6)
    v_mfma_f32_16x16x32_bf16 v[96:99], v[112:115], v[176:179], v[96:99]
    s_mov_b64 exec, 1
    ds_add_u32 v0, v74 offset:12
    s_mov_b64 exec, -1
    v_mfma_f32_16x16x32_bf16 v[96:99], v[212:215], v[148:151], v[96:99]
    ds_read_b128 v[144:147], v11 offset:2432
    v_cvt_pk_bf16_f32 v137, v84, v80
    v_mfma_f32_16x16x32_bf16 v[100:103], v[244:247], v[148:151], v[100:103]
    ds_read_b128 v[148:151], v11 offset:2496
    v_cvt_pk_bf16_f32 v139, v85, v81
    v_mfma_f32_16x16x32_bf16 v[96:99], v[116:119], v[180:183], v[96:99]
    v_cvt_pk_bf16_f32 v141, v86, v82
    v_cvt_pk_bf16_f32 v143, v87, v83
    v_mfma_f32_16x16x32_bf16 v[96:99], v[208:211], v[152:155], v[96:99]
    v_mfma_f32_16x16x32_bf16 v[100:103], v[240:243], v[152:155], v[100:103]
    ds_read_b128 v[152:155], v11 offset:2560
    s_waitcnt lgkmcnt(8)
    v_mfma_f32_16x16x32_bf16 v[96:99], v[120:123], v[168:171], v[96:99]
    v_mfma_f32_16x16x32_bf16 v[96:99], v[204:207], v[156:159], v[96:99]
    v_mfma_f32_16x16x32_bf16 v[100:103], v[236:239], v[156:159], v[100:103]
    ds_read_b128 v[156:159], v11 offset:2624
    v_mfma_f32_16x16x32_bf16 v[92:95], v[56:59], v[48:51], 0
    v_mfma_f32_16x16x32_bf16 v[4:7], v[56:59], v[52:55], 0
    v_mfma_f32_16x16x32_bf16 v[76:79], v[56:59], v[40:43], 0
    ds_read_b128 v[56:59], v11 offset:2688
    s_waitcnt lgkmcnt(8)
    v_mfma_f32_16x16x32_bf16 v[96:99], v[124:127], v[172:175], v[96:99]
    ds_read2_b32 v[40:41], v18 offset0:48 offset1:49
    ds_read2_b32 v[42:43], v18 offset0:50 offset1:51
    v_mfma_f32_16x16x32_bf16 v[96:99], v[200:203], v[60:63], v[96:99]
    v_mfma_f32_16x16x32_bf16 v[100:103], v[232:235], v[60:63], v[100:103]
    ds_read_b128 v[60:63], v11 offset:2480
    v_cvt_pk_bf16_f32 v136, v92, v4
    v_mfma_f32_16x16x32_bf16 v[96:99], v[128:131], v[160:163], v[96:99]
    v_cvt_pk_bf16_f32 v138, v93, v5
    v_cvt_pk_bf16_f32 v140, v94, v6
    v_mfma_f32_16x16x32_bf16 v[96:99], v[196:199], v[64:67], v[96:99]
    v_cvt_pk_bf16_f32 v142, v95, v7
    v_cvt_pk_bf16_f32 v36, v76, v88
    v_mfma_f32_16x16x32_bf16 v[100:103], v[228:231], v[64:67], v[100:103]
    ds_read_b128 v[64:67], v11 offset:2752
    s_waitcnt lgkmcnt(8)
    v_mfma_f32_16x16x32_bf16 v[96:99], v[132:135], v[164:167], v[96:99]
    v_cvt_pk_bf16_f32 v37, v77, v89
    v_cvt_pk_bf16_f32 v38, v78, v90
    v_mfma_f32_16x16x32_bf16 v[96:99], v[192:195], v[68:71], v[96:99]
    v_cvt_pk_bf16_f32 v39, v79, v91
    v_mfma_f32_16x16x32_bf16 v[100:103], v[224:227], v[68:71], v[100:103]
    ds_read_b128 v[68:71], v11 offset:2816
    s_waitcnt lgkmcnt(3)
    v_mfma_f32_16x16x32_bf16 v[96:99], v[24:27], v[40:43], v[96:99]
    v_mfma_f32_16x16x32_bf16 v[96:99], v[188:191], v[144:147], v[96:99]
    v_mfma_f32_16x16x32_bf16 v[100:103], v[220:223], v[144:147], v[100:103]
    ds_read_b128 v[144:147], v11 offset:2880
    v_mfma_f32_16x16x32_bf16 v[96:99], v[184:187], v[148:151], v[96:99]
    v_mfma_f32_16x16x32_bf16 v[100:103], v[216:219], v[148:151], v[100:103]
    v_mfma_f32_16x16x32_bf16 v[104:107], v[248:251], v[148:151], v[104:107]
    v_mfma_f32_16x16x32_bf16 v[84:87], v[148:151], v[48:51], 0
    v_mfma_f32_16x16x32_bf16 v[80:83], v[148:151], v[52:55], 0
    ds_read_b128 v[148:151], v11 offset:2944
    v_mfma_f32_16x16x32_bf16 v[100:103], v[120:123], v[176:179], v[100:103]
    v_mfma_f32_16x16x32_bf16 v[100:103], v[212:215], v[152:155], v[100:103]
    v_mfma_f32_16x16x32_bf16 v[104:107], v[244:247], v[152:155], v[104:107]
    v_cvt_pk_bf16_f32 v22, v96, v97
    v_cvt_pk_bf16_f32 v23, v98, v99
    v_mfma_f32_16x16x32_bf16 v[100:103], v[124:127], v[180:183], v[100:103]
    ds_write_b64 v13, v[22:23] offset:2560
    s_mov_b64 exec, 1
    ds_add_u32 v0, v74 offset:16
    s_mov_b64 exec, -1
    s_setprio 0
    v_mfma_f32_16x16x32_bf16 v[100:103], v[208:211], v[156:159], v[100:103]
    ds_read_b128 v[152:155], v11 offset:3008
    v_cvt_pk_bf16_f32 v113, v84, v80
    v_mfma_f32_16x16x32_bf16 v[104:107], v[240:243], v[156:159], v[104:107]
    ds_read_b128 v[156:159], v11 offset:3072
    v_cvt_pk_bf16_f32 v115, v85, v81
    v_mfma_f32_16x16x32_bf16 v[100:103], v[128:131], v[168:171], v[100:103]
    v_cvt_pk_bf16_f32 v117, v86, v82
    v_cvt_pk_bf16_f32 v119, v87, v83
    v_mfma_f32_16x16x32_bf16 v[100:103], v[204:207], v[56:59], v[100:103]
    v_mfma_f32_16x16x32_bf16 v[104:107], v[236:239], v[56:59], v[104:107]
    ds_read_b128 v[56:59], v11 offset:3136
    s_waitcnt lgkmcnt(8)
    v_mfma_f32_16x16x32_bf16 v[96:99], v[60:63], v[48:51], 0
    ds_read2_b32 v[44:45], v18 offset0:32 offset1:33
    ds_read2_b32 v[46:47], v18 offset0:34 offset1:35
    v_mfma_f32_16x16x32_bf16 v[92:95], v[60:63], v[52:55], 0
    ds_read_b128 v[60:63], v11 offset:3200
    v_mfma_f32_16x16x32_bf16 v[100:103], v[132:135], v[172:175], v[100:103]
    v_mfma_f32_16x16x32_bf16 v[100:103], v[200:203], v[64:67], v[100:103]
    v_mfma_f32_16x16x32_bf16 v[104:107], v[232:235], v[64:67], v[104:107]
    ds_read_b128 v[64:67], v11 offset:2992
    s_waitcnt lgkmcnt(10)
    v_mfma_f32_16x16x32_bf16 v[100:103], v[136:139], v[160:163], v[100:103]
    v_mfma_f32_16x16x32_bf16 v[100:103], v[196:199], v[68:71], v[100:103]
    v_cvt_pk_bf16_f32 v112, v96, v92
    v_cvt_pk_bf16_f32 v114, v97, v93
    v_mfma_f32_16x16x32_bf16 v[104:107], v[228:231], v[68:71], v[104:107]
    ds_read_b128 v[68:71], v11 offset:3264
    v_cvt_pk_bf16_f32 v116, v98, v94
    v_mfma_f32_16x16x32_bf16 v[100:103], v[140:143], v[164:167], v[100:103]
    v_cvt_pk_bf16_f32 v118, v99, v95
    v_mfma_f32_16x16x32_bf16 v[100:103], v[192:195], v[144:147], v[100:103]
    v_mfma_f32_16x16x32_bf16 v[104:107], v[224:227], v[144:147], v[104:107]
    ds_read_b128 v[144:147], v11 offset:3328
    s_waitcnt lgkmcnt(8)
    v_mfma_f32_16x16x32_bf16 v[100:103], v[28:31], v[40:43], v[100:103]
    v_mfma_f32_16x16x32_bf16 v[100:103], v[188:191], v[148:151], v[100:103]
    v_mfma_f32_16x16x32_bf16 v[104:107], v[220:223], v[148:151], v[104:107]
    ds_read_b128 v[148:151], v11 offset:3392
    s_waitcnt lgkmcnt(5)
    v_mfma_f32_16x16x32_bf16 v[100:103], v[24:27], v[44:47], v[100:103]
    v_mfma_f32_16x16x32_bf16 v[100:103], v[184:187], v[152:155], v[100:103]
    v_mfma_f32_16x16x32_bf16 v[104:107], v[216:219], v[152:155], v[104:107]
    v_mfma_f32_16x16x32_bf16 v[108:111], v[248:251], v[152:155], v[108:111]
    v_mfma_f32_16x16x32_bf16 v[4:7], v[152:155], v[48:51], 0
    v_mfma_f32_16x16x32_bf16 v[76:79], v[152:155], v[52:55], 0
    ds_read_b128 v[152:155], v11 offset:3456
    v_mfma_f32_16x16x32_bf16 v[104:107], v[132:135], v[180:183], v[104:107]
    v_mfma_f32_16x16x32_bf16 v[104:107], v[128:131], v[176:179], v[104:107]
    v_mfma_f32_16x16x32_bf16 v[104:107], v[212:215], v[156:159], v[104:107]
    v_cvt_pk_bf16_f32 v22, v100, v101
    v_cvt_pk_bf16_f32 v23, v102, v103
    v_mfma_f32_16x16x32_bf16 v[108:111], v[244:247], v[156:159], v[108:111]
    ds_write_b64 v13, v[22:23] offset:3200
    s_mov_b64 exec, 1
    ds_add_u32 v0, v74 offset:20
    s_mov_b64 exec, -1
    v_mfma_f32_16x16x32_bf16 v[104:107], v[136:139], v[168:171], v[104:107]
    ds_read_b128 v[156:159], v11 offset:3520
    v_cvt_pk_bf16_f32 v121, v4, v76
    v_mfma_f32_16x16x32_bf16 v[104:107], v[208:211], v[56:59], v[104:107]
    v_cvt_pk_bf16_f32 v123, v5, v77
    v_cvt_pk_bf16_f32 v125, v6, v78
    v_mfma_f32_16x16x32_bf16 v[108:111], v[240:243], v[56:59], v[108:111]
    ds_read_b128 v[56:59], v11 offset:3584
    s_waitcnt lgkmcnt(8)
    v_mfma_f32_16x16x32_bf16 v[104:107], v[140:143], v[172:175], v[104:107]
    v_cvt_pk_bf16_f32 v127, v7, v79
    v_mfma_f32_16x16x32_bf16 v[104:107], v[204:207], v[60:63], v[104:107]
    v_mfma_f32_16x16x32_bf16 v[108:111], v[236:239], v[60:63], v[108:111]
    ds_read_b128 v[60:63], v11 offset:3648
    v_mfma_f32_16x16x32_bf16 v[100:103], v[64:67], v[48:51], 0
    v_mfma_f32_16x16x32_bf16 v[88:91], v[64:67], v[52:55], 0
    ds_read_b128 v[64:67], v11 offset:3712
    s_waitcnt lgkmcnt(8)
    v_mfma_f32_16x16x32_bf16 v[104:107], v[112:115], v[160:163], v[104:107]
    ds_read2_b32 v[48:49], v18 offset0:16 offset1:17
    ds_read2_b32 v[50:51], v18 offset0:18 offset1:19
    v_mfma_f32_16x16x32_bf16 v[104:107], v[200:203], v[68:71], v[104:107]
    v_mfma_f32_16x16x32_bf16 v[108:111], v[232:235], v[68:71], v[108:111]
    ds_read_b128 v[68:71], v11 offset:3776
    v_cvt_pk_bf16_f32 v120, v100, v88
    v_mfma_f32_16x16x32_bf16 v[104:107], v[116:119], v[164:167], v[104:107]
    v_cvt_pk_bf16_f32 v122, v101, v89
    v_cvt_pk_bf16_f32 v124, v102, v90
    v_mfma_f32_16x16x32_bf16 v[104:107], v[196:199], v[144:147], v[104:107]
    v_cvt_pk_bf16_f32 v126, v103, v91
    v_mfma_f32_16x16x32_bf16 v[108:111], v[228:231], v[144:147], v[108:111]
    ds_read_b128 v[144:147], v11 offset:3840
    s_waitcnt lgkmcnt(10)
    v_mfma_f32_16x16x32_bf16 v[104:107], v[32:35], v[40:43], v[104:107]
    v_mfma_f32_16x16x32_bf16 v[104:107], v[192:195], v[148:151], v[104:107]
    v_mfma_f32_16x16x32_bf16 v[108:111], v[224:227], v[148:151], v[108:111]
    ds_read_b128 v[148:151], v11 offset:3904
    v_mfma_f32_16x16x32_bf16 v[104:107], v[28:31], v[44:47], v[104:107]
    v_mfma_f32_16x16x32_bf16 v[104:107], v[188:191], v[152:155], v[104:107]
    v_mfma_f32_16x16x32_bf16 v[108:111], v[220:223], v[152:155], v[108:111]
    ds_read_b128 v[152:155], v11 offset:3968
    s_waitcnt lgkmcnt(8)
    s_waitcnt lgkmcnt(4)
    v_mfma_f32_16x16x32_bf16 v[104:107], v[24:27], v[48:51], v[104:107]
    v_mfma_f32_16x16x32_bf16 v[104:107], v[184:187], v[156:159], v[104:107]
    v_mfma_f32_16x16x32_bf16 v[108:111], v[216:219], v[156:159], v[108:111]
    ds_read_b128 v[156:159], v11 offset:4032
    v_mfma_f32_16x16x32_bf16 v[108:111], v[140:143], v[180:183], v[108:111]
    v_mfma_f32_16x16x32_bf16 v[108:111], v[136:139], v[176:179], v[108:111]
    v_mfma_f32_16x16x32_bf16 v[108:111], v[212:215], v[56:59], v[108:111]
    v_mfma_f32_16x16x32_bf16 v[108:111], v[112:115], v[168:171], v[108:111]
    v_mfma_f32_16x16x32_bf16 v[108:111], v[208:211], v[60:63], v[108:111]
    v_mfma_f32_16x16x32_bf16 v[108:111], v[116:119], v[172:175], v[108:111]
    v_cvt_pk_bf16_f32 v22, v104, v105
    v_cvt_pk_bf16_f32 v23, v106, v107
    v_mfma_f32_16x16x32_bf16 v[108:111], v[204:207], v[64:67], v[108:111]
    ds_write_b64 v13, v[22:23] offset:3840
    s_waitcnt lgkmcnt(4)
    v_mfma_f32_16x16x32_bf16 v[108:111], v[120:123], v[160:163], v[108:111]
    s_mov_b64 exec, 1
    ds_add_u32 v0, v74 offset:24
    s_mov_b64 exec, -1
    v_mfma_f32_16x16x32_bf16 v[108:111], v[200:203], v[68:71], v[108:111]
    ds_read2_b32 v[52:53], v18 offset0:0 offset1:1
    ds_read2_b32 v[54:55], v18 offset0:2 offset1:3
    v_mfma_f32_16x16x32_bf16 v[108:111], v[36:39], v[40:43], v[108:111]
    v_mfma_f32_16x16x32_bf16 v[108:111], v[124:127], v[164:167], v[108:111]
    v_mfma_f32_16x16x32_bf16 v[108:111], v[196:199], v[144:147], v[108:111]
    s_waitcnt lgkmcnt(5)
    v_mfma_f32_16x16x32_bf16 v[108:111], v[32:35], v[44:47], v[108:111]
    v_mfma_f32_16x16x32_bf16 v[108:111], v[192:195], v[148:151], v[108:111]
    v_mfma_f32_16x16x32_bf16 v[108:111], v[28:31], v[48:51], v[108:111]
    v_mfma_f32_16x16x32_bf16 v[108:111], v[188:191], v[152:155], v[108:111]
    s_waitcnt lgkmcnt(4)
    s_waitcnt lgkmcnt(0)
    v_mfma_f32_16x16x32_bf16 v[108:111], v[24:27], v[52:55], v[108:111]
    v_mfma_f32_16x16x32_bf16 v[108:111], v[184:187], v[156:159], v[108:111]
    s_nop 7
    v_cvt_pk_bf16_f32 v22, v108, v109
    v_cvt_pk_bf16_f32 v23, v110, v111
    ds_write_b64 v13, v[22:23] offset:4480
    s_mov_b64 exec, 1
    ds_add_u32 v0, v74 offset:28
    s_mov_b64 exec, -1
    s_branch L_fin
L_lo:
    s_setprio 0
    v_mov_b32 v76, 0
    v_mov_b32 v77, 0
    v_mov_b32 v78, 0
    v_mov_b32 v79, 0
    ds_write_b128 v22, v[76:79] offset:256
    ds_read_b32 v1, v75 offset:40
    s_waitcnt lgkmcnt(0)
L_cp:
    v_readfirstlane_b32 s42, v1
    s_nop 0
    s_cmp_eq_u32 s42, 1
    s_cbranch_scc1 L_rp
    s_sleep 1
    ds_read_b32 v1, v75 offset:40
    s_waitcnt lgkmcnt(0)
    s_branch L_cp
L_rp:
    ds_read_b128 v[144:147], v12 offset:0
    ds_read_b128 v[148:151], v12 offset:1024
    ds_read_b128 v[152:155], v12 offset:4576
    ds_read_b128 v[156:159], v12 offset:5600
    s_nop 3
    s_waitcnt lgkmcnt(0)
    v_add_f32 v128, v128, v144
    v_add_f32 v129, v129, v145
    v_add_f32 v130, v130, v146
    v_add_f32 v131, v131, v147
    v_add_f32 v132, v132, v148
    v_add_f32 v133, v133, v149
    v_add_f32 v134, v134, v150
    v_add_f32 v135, v135, v151
    v_add_f32 v136, v136, v152
    v_add_f32 v137, v137, v153
    v_add_f32 v138, v138, v154
    v_add_f32 v139, v139, v155
    v_add_f32 v140, v140, v156
    v_add_f32 v141, v141, v157
    v_add_f32 v128, v128, v21
    v_cvt_pk_bf16_f32 v88, v135, v134
    v_cvt_pk_bf16_f32 v89, v133, v132
    v_cvt_pk_bf16_f32 v90, v131, v130
    v_cvt_pk_bf16_f32 v91, v129, v128
    ds_write_b128 v8, v[88:91] offset:16
    v_cvt_pk_bf16_f32 v92, v136, v135
    v_cvt_pk_bf16_f32 v93, v134, v133
    v_cvt_pk_bf16_f32 v94, v132, v131
    v_cvt_pk_bf16_f32 v95, v130, v129
    ds_write_b128 v8, v[92:95] offset:1104
    v_and_b32 v88, 0xffff0000, v92
    v_mov_b32 v89, v92
    s_mov_b32 exec_lo, 0
    s_mov_b32 exec_hi, 0x80000000
    ds_write_b64 v8, v[88:89] offset:8
    ds_write_b32 v8, v92 offset:1100
    s_mov_b64 exec, 1
    ds_write_b16_d16_hi v8, v91 offset:1120
    s_mov_b64 exec, -1
    v_cvt_pk_bf16_f32 v93, v139, v138
    v_cvt_pk_bf16_f32 v94, v140, v141
    ds_write_b32 v10, v93
    ds_write_b16 v9, v94 offset:64
    ds_write_b16_d16_hi v9, v94
    s_mov_b64 exec, 1
    ds_add_u32 v0, v74 offset:48
    s_mov_b64 exec, -1
    ds_read2_b32 v[212:213], v17 offset0:128 offset1:129
    ds_read2_b32 v[214:215], v17 offset0:130 offset1:131
    ds_read2_b32 v[208:209], v17 offset0:144 offset1:145
    ds_read2_b32 v[210:211], v17 offset0:146 offset1:147
    ds_read2_b32 v[204:205], v17 offset0:160 offset1:161
    ds_read2_b32 v[206:207], v17 offset0:162 offset1:163
    ds_read2_b32 v[200:201], v17 offset0:176 offset1:177
    ds_read2_b32 v[202:203], v17 offset0:178 offset1:179
    ds_read2_b32 v[196:197], v17 offset0:192 offset1:193
    ds_read2_b32 v[198:199], v17 offset0:194 offset1:195
    ds_read2_b32 v[192:193], v17 offset0:208 offset1:209
    ds_read2_b32 v[194:195], v17 offset0:210 offset1:211
    ds_read2_b32 v[188:189], v17 offset0:224 offset1:225
    ds_read2_b32 v[190:191], v17 offset0:226 offset1:227
    ds_read2_b32 v[184:185], v17 offset0:240 offset1:241
    ds_read2_b32 v[186:187], v17 offset0:242 offset1:243
    ds_read_b128 v[40:43], v20 offset:0
    ds_read_b128 v[44:47], v20 offset:1024
    ds_read_b128 v[48:51], v20 offset:2048
    ds_read_b128 v[52:55], v20 offset:3072
    ds_read_b32 v1, v0 offset:36
    s_waitcnt lgkmcnt(0)
L_cha:
    v_readfirstlane_b32 s42, v1
    s_nop 0
    s_cmp_eq_u32 s42, 4
    s_cbranch_scc1 L_rha
    s_sleep 1
    ds_read_b32 v1, v0 offset:36
    s_waitcnt lgkmcnt(0)
    s_branch L_cha
L_rha:
    ds_read_b128 v[56:59], v11 offset:0
    ds_read_b128 v[60:63], v11 offset:64
    ds_read_b128 v[64:67], v11 offset:128
    ds_read_b128 v[68:71], v11 offset:192
    ds_read_b128 v[144:147], v11 offset:256
    ds_read_b128 v[148:151], v11 offset:320
    ds_read_b128 v[152:155], v11 offset:384
    ds_read_b128 v[156:159], v11 offset:448
    ds_read_b32 v21, v0 offset:56
    s_waitcnt lgkmcnt(0)
L_chg:
    v_readfirstlane_b32 s42, v21
    s_nop 0
    s_cmp_eq_u32 s42, 6
    s_cbranch_scc1 L_rhg
    s_sleep 1
    ds_read_b32 v21, v0 offset:56
    s_waitcnt lgkmcnt(0)
    s_branch L_chg
L_rhg:
    s_setprio 3
    ds_read2_b32 v[244:245], v17 offset0:0 offset1:1
    ds_read2_b32 v[246:247], v17 offset0:2 offset1:3
    ds_read2_b32 v[240:241], v17 offset0:16 offset1:17
    ds_read2_b32 v[242:243], v17 offset0:18 offset1:19
    ds_read2_b32 v[236:237], v17 offset0:32 offset1:33
    ds_read2_b32 v[238:239], v17 offset0:34 offset1:35
    v_mfma_f32_16x16x32_bf16 v[80:83], v[212:215], v[56:59], 0
    v_mov_b32 v2, s40
    ds_read_b128 v[252:255], v20 offset:4096
    s_waitcnt lgkmcnt(5)
    v_mfma_f32_16x16x32_bf16 v[84:87], v[244:247], v[56:59], 0
    ds_read_b128 v[56:59], v11 offset:512
    ds_read_u16 v2, v2 offset:2592
    ds_read2_b32 v[232:233], v17 offset0:48 offset1:49
    ds_read2_b32 v[234:235], v17 offset0:50 offset1:51
    v_mfma_f32_16x16x32_bf16 v[80:83], v[208:211], v[60:63], v[80:83]
    s_waitcnt lgkmcnt(7)
    v_mfma_f32_16x16x32_bf16 v[84:87], v[240:243], v[60:63], v[84:87]
    ds_read_b128 v[60:63], v11 offset:576
    ds_read2_b32 v[228:229], v17 offset0:64 offset1:65
    ds_read2_b32 v[230:231], v17 offset0:66 offset1:67
    v_mfma_f32_16x16x32_bf16 v[80:83], v[204:207], v[64:67], v[80:83]
    s_waitcnt lgkmcnt(8)
    v_mfma_f32_16x16x32_bf16 v[84:87], v[236:239], v[64:67], v[84:87]
    ds_read_b128 v[64:67], v11 offset:640
    ds_read2_b32 v[224:225], v17 offset0:80 offset1:81
    ds_read2_b32 v[226:227], v17 offset0:82 offset1:83
    v_mfma_f32_16x16x32_bf16 v[80:83], v[200:203], v[68:71], v[80:83]
    s_waitcnt lgkmcnt(6)
    v_mfma_f32_16x16x32_bf16 v[84:87], v[232:235], v[68:71], v[84:87]
    ds_read_b128 v[68:71], v11 offset:432
    ds_read2_b32 v[220:221], v17 offset0:96 offset1:97
    ds_read2_b32 v[222:223], v17 offset0:98 offset1:99
    v_mfma_f32_16x16x32_bf16 v[80:83], v[196:199], v[144:147], v[80:83]
    v_lshl_or_b32 v2, v2, 16, v2
    v_and_b32 v252, v2, v252
    s_waitcnt lgkmcnt(6)
    v_mfma_f32_16x16x32_bf16 v[84:87], v[228:231], v[144:147], v[84:87]
    ds_read_b128 v[144:147], v11 offset:704
    v_and_b32 v253, v2, v253
    ds_read2_b32 v[216:217], v17 offset0:112 offset1:113
    ds_read2_b32 v[218:219], v17 offset0:114 offset1:115
    v_mfma_f32_16x16x32_bf16 v[80:83], v[192:195], v[148:151], v[80:83]
    v_and_b32 v254, v2, v254
    v_and_b32 v255, v2, v255
    s_waitcnt lgkmcnt(6)
    v_mfma_f32_16x16x32_bf16 v[84:87], v[224:227], v[148:151], v[84:87]
    ds_read_b128 v[148:151], v11 offset:768
    v_mfma_f32_16x16x32_bf16 v[80:83], v[188:191], v[152:155], v[80:83]
    s_waitcnt lgkmcnt(4)
    v_mfma_f32_16x16x32_bf16 v[84:87], v[220:223], v[152:155], v[84:87]
    ds_read_b128 v[152:155], v11 offset:832
    v_mfma_f32_16x16x32_bf16 v[80:83], v[184:187], v[156:159], v[80:83]
    s_waitcnt lgkmcnt(2)
    v_mfma_f32_16x16x32_bf16 v[84:87], v[216:219], v[156:159], v[84:87]
    v_mfma_f32_16x16x32_bf16 v[96:99], v[252:255], v[156:159], 0
    v_mfma_f32_16x16x32_bf16 v[88:91], v[156:159], v[48:51], 0
    v_mfma_f32_16x16x32_bf16 v[92:95], v[156:159], v[52:55], 0
    v_mfma_f32_16x16x32_bf16 v[104:107], v[156:159], v[44:47], 0
    ds_read_b128 v[156:159], v11 offset:896
    v_mfma_f32_16x16x32_bf16 v[84:87], v[212:215], v[56:59], v[84:87]
    v_cvt_pk_bf16_f32 v22, v80, v81
    v_cvt_pk_bf16_f32 v23, v82, v83
    v_mfma_f32_16x16x32_bf16 v[84:87], v[208:211], v[60:63], v[84:87]
    ds_write_b64 v13, v[22:23] offset:0
    s_mov_b64 exec, 1
    ds_add_u32 v0, v74 offset:0
    s_mov_b64 exec, -1
    ds_read_b32 v21, v0 offset:0
    s_waitcnt lgkmcnt(0)
L_ct0:
    v_readfirstlane_b32 s42, v21
    s_nop 0
    s_cmp_eq_u32 s42, 6
    s_cbranch_scc1 L_rt0
    ds_read_b32 v21, v0 offset:0
    s_waitcnt lgkmcnt(0)
    s_branch L_ct0
L_rt0:
    ds_read_b64_tr_b16 v[76:77], v14 offset:0
    ds_read_b64_tr_b16 v[78:79], v14 offset:35072
    ds_read_b64_tr_b16 v[4:5], v14 offset:160
    ds_read_b64_tr_b16 v[6:7], v14 offset:35232
    v_mfma_f32_16x16x32_bf16 v[84:87], v[204:207], v[64:67], v[84:87]
    ds_read_b128 v[56:59], v11 offset:960
    ds_read_b128 v[60:63], v11 offset:944
    v_mfma_f32_16x16x32_bf16 v[80:83], v[68:71], v[48:51], 0
    ds_read_b128 v[64:67], v11 offset:1472
    v_cvt_pk_bf16_f32 v113, v88, v92
    v_mfma_f32_16x16x32_bf16 v[108:111], v[68:71], v[52:55], 0
    v_cvt_pk_bf16_f32 v115, v89, v93
    s_waitcnt lgkmcnt(3)
    global_store_dwordx3 v15, v[76:78], s[34:35]
    global_store_dwordx3 v15, v[4:6], s[54:55]
    v_add_u32 v15, 655360, v15
    v_cvt_pk_bf16_f32 v117, v90, v94
    v_cvt_pk_bf16_f32 v119, v91, v95
    v_mfma_f32_16x16x32_bf16 v[88:91], v[68:71], v[40:43], 0
    ds_read_b128 v[68:71], v11 offset:1536
    v_cvt_pk_bf16_f32 v112, v80, v108
    v_mfma_f32_16x16x32_bf16 v[84:87], v[200:203], v[144:147], v[84:87]
    ds_read_b128 v[144:147], v11 offset:1600
    v_cvt_pk_bf16_f32 v114, v81, v109
    v_mfma_f32_16x16x32_bf16 v[84:87], v[196:199], v[148:151], v[84:87]
    ds_read2_b32 v[248:249], v16 offset0:0 offset1:1
    ds_read2_b32 v[250:251], v16 offset0:2 offset1:3
    v_mfma_f32_16x16x32_bf16 v[84:87], v[192:195], v[152:155], v[84:87]
    ds_read_b128 v[148:151], v11 offset:1664
    ds_read_b128 v[152:155], v11 offset:1456
    v_mfma_f32_16x16x32_bf16 v[84:87], v[188:191], v[156:159], v[84:87]
    ds_read_b128 v[156:159], v11 offset:1728
    s_waitcnt lgkmcnt(8)
    v_mfma_f32_16x16x32_bf16 v[84:87], v[184:187], v[56:59], v[84:87]
    v_cvt_pk_bf16_f32 v116, v82, v110
    v_cvt_pk_bf16_f32 v118, v83, v111
    v_mfma_f32_16x16x32_bf16 v[100:103], v[252:255], v[56:59], 0
    v_cvt_pk_bf16_f32 v24, v88, v104
    v_cvt_pk_bf16_f32 v25, v89, v105
    v_mfma_f32_16x16x32_bf16 v[92:95], v[56:59], v[48:51], 0
    v_cvt_pk_bf16_f32 v26, v90, v106
    v_cvt_pk_bf16_f32 v27, v91, v107
    v_mfma_f32_16x16x32_bf16 v[80:83], v[56:59], v[52:55], 0
    v_cvt_pk_bf16_f32 v22, v84, v85
    v_cvt_pk_bf16_f32 v23, v86, v87
    v_mfma_f32_16x16x32_bf16 v[108:111], v[56:59], v[44:47], 0
    ds_write_b64 v13, v[22:23] offset:640
    s_mov_b64 exec, 1
    ds_add_u32 v0, v74 offset:4
    s_mov_b64 exec, -1
    ds_read_b32 v21, v0 offset:4
    s_waitcnt lgkmcnt(0)
L_ct1:
    v_readfirstlane_b32 s42, v21
    s_nop 0
    s_cmp_eq_u32 s42, 6
    s_cbranch_scc1 L_rt1
    ds_read_b32 v21, v0 offset:4
    s_waitcnt lgkmcnt(0)
    s_branch L_ct1
L_rt1:
    ds_read_b64_tr_b16 v[76:77], v14 offset:640
    ds_read_b64_tr_b16 v[78:79], v14 offset:35712
    ds_read_b64_tr_b16 v[4:5], v14 offset:800
    ds_read_b64_tr_b16 v[6:7], v14 offset:35872
    v_mfma_f32_16x16x32_bf16 v[84:87], v[60:63], v[48:51], 0
    ds_read_b32 v1, v0 offset:32
    ds_read_b128 v[56:59], v11 offset:1792
    v_mfma_f32_16x16x32_bf16 v[88:91], v[60:63], v[52:55], 0
    v_cvt_pk_bf16_f32 v121, v92, v80
    v_cvt_pk_bf16_f32 v123, v93, v81
    v_mfma_f32_16x16x32_bf16 v[104:107], v[60:63], v[40:43], 0
    ds_read_b128 v[60:63], v11 offset:1856
    s_waitcnt lgkmcnt(3)
    global_store_dwordx3 v15, v[76:78], s[34:35]
    global_store_dwordx3 v15, v[4:6], s[54:55]
    v_add_u32 v15, 1966080, v15
    s_setprio 1
    v_mfma_f32_16x16x32_bf16 v[96:99], v[248:251], v[64:67], v[96:99]
    v_cvt_pk_bf16_f32 v125, v94, v82
    v_cvt_pk_bf16_f32 v127, v95, v83
    v_mfma_f32_16x16x32_bf16 v[92:95], v[64:67], v[48:51], 0
    v_cvt_pk_bf16_f32 v120, v84, v88
    v_cvt_pk_bf16_f32 v122, v85, v89
    v_mfma_f32_16x16x32_bf16 v[80:83], v[64:67], v[52:55], 0
    ds_read_b128 v[64:67], v11 offset:1920
    v_cvt_pk_bf16_f32 v124, v86, v90
    v_mfma_f32_16x16x32_bf16 v[96:99], v[244:247], v[68:71], v[96:99]
    ds_read_b128 v[68:71], v11 offset:1984
    v_cvt_pk_bf16_f32 v126, v87, v91
    v_mfma_f32_16x16x32_bf16 v[96:99], v[240:243], v[144:147], v[96:99]
    v_cvt_pk_bf16_f32 v28, v104, v108
    v_cvt_pk_bf16_f32 v29, v105, v109
    v_mfma_f32_16x16x32_bf16 v[96:99], v[236:239], v[148:151], v[96:99]
    v_cvt_pk_bf16_f32 v30, v106, v110
    v_cvt_pk_bf16_f32 v31, v107, v111
    v_mfma_f32_16x16x32_bf16 v[84:87], v[152:155], v[48:51], 0
    v_cvt_pk_bf16_f32 v129, v92, v80
    v_cvt_pk_bf16_f32 v131, v93, v81
    v_mfma_f32_16x16x32_bf16 v[88:91], v[152:155], v[52:55], 0
    v_cvt_pk_bf16_f32 v133, v94, v82
    v_cvt_pk_bf16_f32 v135, v95, v83
    v_mfma_f32_16x16x32_bf16 v[96:99], v[232:235], v[156:159], v[96:99]
    ds_read_b64 v[176:177], v19 offset:0
    s_waitcnt lgkmcnt(3)
    v_mfma_f32_16x16x32_bf16 v[96:99], v[228:231], v[56:59], v[96:99]
    ds_read_b64 v[178:179], v19 offset:8
    ds_read_b64 v[180:181], v19 offset:16
    v_mfma_f32_16x16x32_bf16 v[96:99], v[224:227], v[60:63], v[96:99]
    ds_read_b64 v[182:183], v19 offset:24
    s_waitcnt lgkmcnt(4)
    v_mfma_f32_16x16x32_bf16 v[96:99], v[220:223], v[64:67], v[96:99]
    ds_read_b64 v[168:169], v19 offset:128
    ds_read_b64 v[170:171], v19 offset:136
    v_mfma_f32_16x16x32_bf16 v[96:99], v[216:219], v[68:71], v[96:99]
    ds_read_b64 v[172:173], v19 offset:144
    ds_read_b64 v[174:175], v19 offset:152
    v_mfma_f32_16x16x32_bf16 v[100:103], v[248:251], v[68:71], v[100:103]
L_cah:
    v_readfirstlane_b32 s43, v1
    s_nop 0
    s_cmp_eq_u32 s43, 2
    s_cbranch_scc1 L_rah
    ds_read_b32 v1, v0 offset:32
    s_waitcnt lgkmcnt(0)
    s_branch L_cah
L_rah:
    ds_read_b128 v[144:147], v11 offset:2048
    v_mfma_f32_16x16x32_bf16 v[104:107], v[68:71], v[48:51], 0
    ds_read_b128 v[148:151], v11 offset:2112
    ds_read_b128 v[152:155], v11 offset:2176
    v_mfma_f32_16x16x32_bf16 v[108:111], v[68:71], v[52:55], 0
    ds_read_b128 v[156:159], v11 offset:1968
    s_waitcnt lgkmcnt(3)
    v_mfma_f32_16x16x32_bf16 v[96:99], v[112:115], v[176:179], v[96:99]
    ds_read_b64 v[160:161], v19 offset:256
    ds_read_b64 v[162:163], v19 offset:264
    v_mfma_f32_16x16x32_bf16 v[96:99], v[212:215], v[144:147], v[96:99]
    ds_read_b128 v[56:59], v11 offset:2240
    ds_read_b128 v[60:63], v11 offset:2304
    v_mfma_f32_16x16x32_bf16 v[100:103], v[244:247], v[144:147], v[100:103]
    ds_read_b128 v[64:67], v11 offset:2368
    s_waitcnt lgkmcnt(6)
    v_mfma_f32_16x16x32_bf16 v[96:99], v[116:119], v[180:183], v[96:99]
    ds_read_b64 v[164:165], v19 offset:272
    ds_read_b64 v[166:167], v19 offset:280
    v_mfma_f32_16x16x32_bf16 v[96:99], v[208:211], v[148:151], v[96:99]
    ds_read_b128 v[68:71], v11 offset:2432
    ds_read_b128 v[144:147], v11 offset:2496
    v_mfma_f32_16x16x32_bf16 v[100:103], v[240:243], v[148:151], v[100:103]
    ds_read_b128 v[148:151], v11 offset:2560
    v_cvt_pk_bf16_f32 v128, v84, v88
    v_mfma_f32_16x16x32_bf16 v[96:99], v[120:123], v[168:171], v[96:99]
    ds_read2_b32 v[40:41], v18 offset0:48 offset1:49
    ds_read2_b32 v[42:43], v18 offset0:50 offset1:51
    v_mfma_f32_16x16x32_bf16 v[96:99], v[204:207], v[152:155], v[96:99]
    v_cvt_pk_bf16_f32 v130, v85, v89
    v_cvt_pk_bf16_f32 v132, v86, v90
    v_mfma_f32_16x16x32_bf16 v[100:103], v[236:239], v[152:155], v[100:103]
    ds_read_b128 v[152:155], v11 offset:2624
    s_waitcnt lgkmcnt(10)
    v_mfma_f32_16x16x32_bf16 v[92:95], v[156:159], v[48:51], 0
    v_cvt_pk_bf16_f32 v134, v87, v91
    v_cvt_pk_bf16_f32 v137, v104, v108
    v_mfma_f32_16x16x32_bf16 v[80:83], v[156:159], v[52:55], 0
    ds_read_b128 v[156:159], v11 offset:2688
    v_cvt_pk_bf16_f32 v139, v105, v109
    v_mfma_f32_16x16x32_bf16 v[96:99], v[124:127], v[172:175], v[96:99]
    v_cvt_pk_bf16_f32 v141, v106, v110
    v_cvt_pk_bf16_f32 v143, v107, v111
    v_mfma_f32_16x16x32_bf16 v[96:99], v[200:203], v[56:59], v[96:99]
    v_mfma_f32_16x16x32_bf16 v[100:103], v[232:235], v[56:59], v[100:103]
    ds_read_b128 v[56:59], v11 offset:2752
    s_waitcnt lgkmcnt(10)
    v_mfma_f32_16x16x32_bf16 v[96:99], v[128:131], v[160:163], v[96:99]
    v_cvt_pk_bf16_f32 v136, v92, v80
    v_cvt_pk_bf16_f32 v138, v93, v81
    v_mfma_f32_16x16x32_bf16 v[96:99], v[196:199], v[60:63], v[96:99]
    v_cvt_pk_bf16_f32 v140, v94, v82
    v_cvt_pk_bf16_f32 v142, v95, v83
    v_mfma_f32_16x16x32_bf16 v[100:103], v[228:231], v[60:63], v[100:103]
    ds_read_b128 v[60:63], v11 offset:2816
    s_waitcnt lgkmcnt(9)
    v_mfma_f32_16x16x32_bf16 v[96:99], v[132:135], v[164:167], v[96:99]
    v_mfma_f32_16x16x32_bf16 v[96:99], v[192:195], v[64:67], v[96:99]
    v_mfma_f32_16x16x32_bf16 v[100:103], v[224:227], v[64:67], v[100:103]
    ds_read_b128 v[64:67], v11 offset:2880
    s_waitcnt lgkmcnt(8)
    s_waitcnt lgkmcnt(5)
    v_mfma_f32_16x16x32_bf16 v[96:99], v[24:27], v[40:43], v[96:99]
    v_mfma_f32_16x16x32_bf16 v[96:99], v[188:191], v[68:71], v[96:99]
    v_mfma_f32_16x16x32_bf16 v[100:103], v[220:223], v[68:71], v[100:103]
    ds_read_b128 v[68:71], v11 offset:2944
    v_mfma_f32_16x16x32_bf16 v[96:99], v[184:187], v[144:147], v[96:99]
    v_mfma_f32_16x16x32_bf16 v[100:103], v[216:219], v[144:147], v[100:103]
    ds_read_b128 v[144:147], v11 offset:3008
    v_mfma_f32_16x16x32_bf16 v[100:103], v[120:123], v[176:179], v[100:103]
    v_mfma_f32_16x16x32_bf16 v[100:103], v[212:215], v[148:151], v[100:103]
    s_waitcnt lgkmcnt(5)
    v_mfma_f32_16x16x32_bf16 v[100:103], v[124:127], v[180:183], v[100:103]
    v_mfma_f32_16x16x32_bf16 v[100:103], v[208:211], v[152:155], v[100:103]
    v_mfma_f32_16x16x32_bf16 v[100:103], v[128:131], v[168:171], v[100:103]
    v_cvt_pk_bf16_f32 v22, v96, v97
    v_cvt_pk_bf16_f32 v23, v98, v99
    v_mfma_f32_16x16x32_bf16 v[100:103], v[204:207], v[156:159], v[100:103]
    ds_write_b64 v13, v[22:23] offset:2560
    s_waitcnt lgkmcnt(4)
    v_mfma_f32_16x16x32_bf16 v[100:103], v[132:135], v[172:175], v[100:103]
    s_mov_b64 exec, 1
    ds_add_u32 v0, v74 offset:16
    s_mov_b64 exec, -1
    ds_read_b32 v21, v0 offset:16
    s_waitcnt lgkmcnt(0)
L_ct4:
    v_readfirstlane_b32 s42, v21
    s_nop 0
    s_cmp_eq_u32 s42, 6
    s_cbranch_scc1 L_rt4
    ds_read_b32 v21, v0 offset:16
    s_waitcnt lgkmcnt(0)
    s_branch L_ct4
L_rt4:
    ds_read_b64_tr_b16 v[76:77], v14 offset:2560
    ds_read_b64_tr_b16 v[78:79], v14 offset:37632
    ds_read_b64_tr_b16 v[4:5], v14 offset:2720
    ds_read_b64_tr_b16 v[6:7], v14 offset:37792
    v_mfma_f32_16x16x32_bf16 v[100:103], v[200:203], v[56:59], v[100:103]
    ds_read2_b32 v[44:45], v18 offset0:32 offset1:33
    ds_read2_b32 v[46:47], v18 offset0:34 offset1:35
    v_mfma_f32_16x16x32_bf16 v[100:103], v[136:139], v[160:163], v[100:103]
    v_mfma_f32_16x16x32_bf16 v[100:103], v[196:199], v[60:63], v[100:103]
    v_mfma_f32_16x16x32_bf16 v[100:103], v[140:143], v[164:167], v[100:103]
    v_mfma_f32_16x16x32_bf16 v[100:103], v[192:195], v[64:67], v[100:103]
    v_mfma_f32_16x16x32_bf16 v[100:103], v[28:31], v[40:43], v[100:103]
    s_waitcnt lgkmcnt(2)
    global_store_dwordx3 v15, v[76:78], s[34:35]
    global_store_dwordx3 v15, v[4:6], s[54:55]
    v_add_u32 v15, 655360, v15
    v_mfma_f32_16x16x32_bf16 v[100:103], v[188:191], v[68:71], v[100:103]
    s_waitcnt lgkmcnt(0)
    v_mfma_f32_16x16x32_bf16 v[100:103], v[24:27], v[44:47], v[100:103]
    v_mfma_f32_16x16x32_bf16 v[100:103], v[184:187], v[144:147], v[100:103]
    s_nop 7
    v_cvt_pk_bf16_f32 v22, v100, v101
    v_cvt_pk_bf16_f32 v23, v102, v103
    ds_write_b64 v13, v[22:23] offset:3200
    s_mov_b64 exec, 1
    ds_add_u32 v0, v74 offset:20
    s_mov_b64 exec, -1
    ds_read_b32 v21, v0 offset:20
    s_waitcnt lgkmcnt(0)
L_ct5:
    v_readfirstlane_b32 s42, v21
    s_nop 0
    s_cmp_eq_u32 s42, 6
    s_cbranch_scc1 L_rt5
    ds_read_b32 v21, v0 offset:20
    s_waitcnt lgkmcnt(0)
    s_branch L_ct5
L_rt5:
    ds_read_b64_tr_b16 v[76:77], v14 offset:3200
    ds_read_b64_tr_b16 v[78:79], v14 offset:38272
    ds_read_b64_tr_b16 v[4:5], v14 offset:3360
    ds_read_b64_tr_b16 v[6:7], v14 offset:38432
    s_waitcnt lgkmcnt(0)
    global_store_dwordx3 v15, v[76:78], s[34:35]
    global_store_dwordx3 v15, v[4:6], s[54:55]
    s_branch L_fin
L_hi:
    s_setprio 1
    ds_read_b64 v[68:69], v84
    ds_read_b64 v[70:71], v84 offset:1024
    s_nop 9
    ds_write_b128 v12, v[128:131] offset:0
    ds_write_b128 v12, v[132:135] offset:1024
    ds_write_b128 v12, v[136:139] offset:4576
    ds_write_b128 v12, v[140:143] offset:5600
    s_mov_b64 exec, 1
    ds_add_u32 v75, v74 offset:40
    s_mov_b64 exec, -1
    s_add_u32 s18, s16, 1310720
    s_addc_u32 s19, s17, 0
    global_load_dwordx3 v[160:162], v4, s[18:19] offset:0
    global_load_dwordx3 v[164:166], v4, s[18:19] offset:1280
    global_load_dwordx3 v[168:170], v4, s[18:19] offset:2560
    global_load_dwordx3 v[172:174], v4, s[18:19] offset:3840
    s_add_u32 s18, s16, 1315840
    s_addc_u32 s19, s17, 0
    global_load_dwordx3 v[176:178], v4, s[18:19] offset:0
    global_load_dwordx3 v[180:182], v4, s[18:19] offset:1280
    global_load_dwordx3 v[184:186], v4, s[18:19] offset:2560
    global_load_dwordx3 v[188:190], v4, s[18:19] offset:3840
    s_waitcnt lgkmcnt(0)
    v_cvt_pk_bf16_f32 v89, v68, v69
    ds_write_addtid_b32 v89 offset:272
    v_pk_mul_f32 v[112:113], v[68:69], v[68:69] op_sel_hi:[1,0]
    v_pk_fma_f32 v[112:113], v[68:69], v[68:69], v[112:113] op_sel:[1,1,0] op_sel_hi:[0,1,1] neg_lo:[1,0,0]
    v_cvt_pk_bf16_f32 v90, v112, v113
    ds_write_addtid_b32 v90 offset:544
    v_pk_mul_f32 v[114:115], v[112:113], v[68:69] op_sel_hi:[1,0]
    v_pk_fma_f32 v[114:115], v[112:113], v[68:69], v[114:115] op_sel:[1,1,0] op_sel_hi:[0,1,1] neg_lo:[1,0,0]
    v_cvt_pk_bf16_f32 v91, v114, v115
    ds_write_addtid_b32 v91 offset:816
    v_pk_mul_f32 v[112:113], v[114:115], v[68:69] op_sel_hi:[1,0]
    v_pk_fma_f32 v[112:113], v[114:115], v[68:69], v[112:113] op_sel:[1,1,0] op_sel_hi:[0,1,1] neg_lo:[1,0,0]
    v_cvt_pk_bf16_f32 v92, v112, v113
    ds_write_addtid_b32 v92 offset:1088
    v_pk_mul_f32 v[114:115], v[112:113], v[68:69] op_sel_hi:[1,0]
    v_pk_fma_f32 v[114:115], v[112:113], v[68:69], v[114:115] op_sel:[1,1,0] op_sel_hi:[0,1,1] neg_lo:[1,0,0]
    v_cvt_pk_bf16_f32 v93, v114, v115
    ds_write_addtid_b32 v93 offset:1360
    v_pk_mul_f32 v[112:113], v[114:115], v[68:69] op_sel_hi:[1,0]
    v_pk_fma_f32 v[112:113], v[114:115], v[68:69], v[112:113] op_sel:[1,1,0] op_sel_hi:[0,1,1] neg_lo:[1,0,0]
    v_cvt_pk_bf16_f32 v94, v112, v113
    ds_write_addtid_b32 v94 offset:1632
    v_pk_mul_f32 v[114:115], v[112:113], v[68:69] op_sel_hi:[1,0]
    v_pk_fma_f32 v[114:115], v[112:113], v[68:69], v[114:115] op_sel:[1,1,0] op_sel_hi:[0,1,1] neg_lo:[1,0,0]
    v_cvt_pk_bf16_f32 v95, v114, v115
    ds_write_addtid_b32 v95 offset:1904
    v_pk_mul_f32 v[112:113], v[114:115], v[68:69] op_sel_hi:[1,0]
    v_pk_fma_f32 v[112:113], v[114:115], v[68:69], v[112:113] op_sel:[1,1,0] op_sel_hi:[0,1,1] neg_lo:[1,0,0]
    v_cvt_pk_bf16_f32 v96, v112, v113
    ds_write_addtid_b32 v96 offset:2176
    v_pk_mul_f32 v[114:115], v[112:113], v[68:69] op_sel_hi:[1,0]
    v_pk_fma_f32 v[114:115], v[112:113], v[68:69], v[114:115] op_sel:[1,1,0] op_sel_hi:[0,1,1] neg_lo:[1,0,0]
    v_cvt_pk_bf16_f32 v97, v114, v115
    ds_write_addtid_b32 v97 offset:2448
    v_pk_mul_f32 v[112:113], v[114:115], v[68:69] op_sel_hi:[1,0]
    v_pk_fma_f32 v[112:113], v[114:115], v[68:69], v[112:113] op_sel:[1,1,0] op_sel_hi:[0,1,1] neg_lo:[1,0,0]
    v_cvt_pk_bf16_f32 v98, v112, v113
    ds_write_addtid_b32 v98 offset:2720
    v_pk_mul_f32 v[114:115], v[112:113], v[68:69] op_sel_hi:[1,0]
    v_pk_fma_f32 v[114:115], v[112:113], v[68:69], v[114:115] op_sel:[1,1,0] op_sel_hi:[0,1,1] neg_lo:[1,0,0]
    v_cvt_pk_bf16_f32 v99, v114, v115
    ds_write_addtid_b32 v99 offset:2992
    v_pk_mul_f32 v[112:113], v[114:115], v[68:69] op_sel_hi:[1,0]
    v_pk_fma_f32 v[112:113], v[114:115], v[68:69], v[112:113] op_sel:[1,1,0] op_sel_hi:[0,1,1] neg_lo:[1,0,0]
    v_cvt_pk_bf16_f32 v100, v112, v113
    ds_write_addtid_b32 v100 offset:3264
    v_pk_mul_f32 v[114:115], v[112:113], v[68:69] op_sel_hi:[1,0]
    v_pk_fma_f32 v[114:115], v[112:113], v[68:69], v[114:115] op_sel:[1,1,0] op_sel_hi:[0,1,1] neg_lo:[1,0,0]
    v_cvt_pk_bf16_f32 v101, v114, v115
    ds_write_addtid_b32 v101 offset:3536
    v_pk_mul_f32 v[112:113], v[114:115], v[68:69] op_sel_hi:[1,0]
    v_pk_fma_f32 v[112:113], v[114:115], v[68:69], v[112:113] op_sel:[1,1,0] op_sel_hi:[0,1,1] neg_lo:[1,0,0]
    v_cvt_pk_bf16_f32 v102, v112, v113
    ds_write_addtid_b32 v102 offset:3808
    v_pk_mul_f32 v[114:115], v[112:113], v[68:69] op_sel_hi:[1,0]
    v_pk_fma_f32 v[114:115], v[112:113], v[68:69], v[114:115] op_sel:[1,1,0] op_sel_hi:[0,1,1] neg_lo:[1,0,0]
    v_cvt_pk_bf16_f32 v103, v114, v115
    ds_write_addtid_b32 v103 offset:4080
    v_pk_mul_f32 v[112:113], v[114:115], v[68:69] op_sel_hi:[1,0]
    v_pk_fma_f32 v[112:113], v[114:115], v[68:69], v[112:113] op_sel:[1,1,0] op_sel_hi:[0,1,1] neg_lo:[1,0,0]
    v_cvt_pk_bf16_f32 v88, v112, v113
    ds_write_addtid_b32 v88 offset:4352
    v_pk_mul_f32 v[114:115], v[112:113], v[68:69] op_sel_hi:[1,0]
    v_pk_fma_f32 v[114:115], v[112:113], v[68:69], v[114:115] op_sel:[1,1,0] op_sel_hi:[0,1,1] neg_lo:[1,0,0]
    v_cvt_pk_bf16_f32 v89, v114, v115
    ds_write_addtid_b32 v89 offset:4624
    v_pk_mul_f32 v[112:113], v[114:115], v[68:69] op_sel_hi:[1,0]
    v_pk_fma_f32 v[112:113], v[114:115], v[68:69], v[112:113] op_sel:[1,1,0] op_sel_hi:[0,1,1] neg_lo:[1,0,0]
    v_cvt_pk_bf16_f32 v90, v112, v113
    ds_write_addtid_b32 v90 offset:4896
    v_pk_mul_f32 v[114:115], v[112:113], v[68:69] op_sel_hi:[1,0]
    v_pk_fma_f32 v[114:115], v[112:113], v[68:69], v[114:115] op_sel:[1,1,0] op_sel_hi:[0,1,1] neg_lo:[1,0,0]
    v_cvt_pk_bf16_f32 v91, v114, v115
    ds_write_addtid_b32 v91 offset:5168
    v_pk_mul_f32 v[112:113], v[114:115], v[68:69] op_sel_hi:[1,0]
    v_pk_fma_f32 v[112:113], v[114:115], v[68:69], v[112:113] op_sel:[1,1,0] op_sel_hi:[0,1,1] neg_lo:[1,0,0]
    v_cvt_pk_bf16_f32 v92, v112, v113
    ds_write_addtid_b32 v92 offset:5440
    v_pk_mul_f32 v[114:115], v[112:113], v[68:69] op_sel_hi:[1,0]
    v_pk_fma_f32 v[114:115], v[112:113], v[68:69], v[114:115] op_sel:[1,1,0] op_sel_hi:[0,1,1] neg_lo:[1,0,0]
    v_cvt_pk_bf16_f32 v93, v114, v115
    ds_write_addtid_b32 v93 offset:5712
    v_pk_mul_f32 v[112:113], v[114:115], v[68:69] op_sel_hi:[1,0]
    v_pk_fma_f32 v[112:113], v[114:115], v[68:69], v[112:113] op_sel:[1,1,0] op_sel_hi:[0,1,1] neg_lo:[1,0,0]
    v_cvt_pk_bf16_f32 v94, v112, v113
    ds_write_addtid_b32 v94 offset:5984
    v_pk_mul_f32 v[114:115], v[112:113], v[68:69] op_sel_hi:[1,0]
    v_pk_fma_f32 v[114:115], v[112:113], v[68:69], v[114:115] op_sel:[1,1,0] op_sel_hi:[0,1,1] neg_lo:[1,0,0]
    v_cvt_pk_bf16_f32 v95, v114, v115
    ds_write_addtid_b32 v95 offset:6256
    v_pk_mul_f32 v[112:113], v[114:115], v[68:69] op_sel_hi:[1,0]
    v_pk_fma_f32 v[112:113], v[114:115], v[68:69], v[112:113] op_sel:[1,1,0] op_sel_hi:[0,1,1] neg_lo:[1,0,0]
    v_cvt_pk_bf16_f32 v96, v112, v113
    ds_write_addtid_b32 v96 offset:6528
    v_pk_mul_f32 v[114:115], v[112:113], v[68:69] op_sel_hi:[1,0]
    v_pk_fma_f32 v[114:115], v[112:113], v[68:69], v[114:115] op_sel:[1,1,0] op_sel_hi:[0,1,1] neg_lo:[1,0,0]
    v_cvt_pk_bf16_f32 v97, v114, v115
    ds_write_addtid_b32 v97 offset:6800
    v_pk_mul_f32 v[112:113], v[114:115], v[68:69] op_sel_hi:[1,0]
    v_pk_fma_f32 v[112:113], v[114:115], v[68:69], v[112:113] op_sel:[1,1,0] op_sel_hi:[0,1,1] neg_lo:[1,0,0]
    v_cvt_pk_bf16_f32 v98, v112, v113
    ds_write_addtid_b32 v98 offset:7072
    v_pk_mul_f32 v[114:115], v[112:113], v[68:69] op_sel_hi:[1,0]
    v_pk_fma_f32 v[114:115], v[112:113], v[68:69], v[114:115] op_sel:[1,1,0] op_sel_hi:[0,1,1] neg_lo:[1,0,0]
    v_cvt_pk_bf16_f32 v99, v114, v115
    ds_write_addtid_b32 v99 offset:7344
    v_pk_mul_f32 v[112:113], v[114:115], v[68:69] op_sel_hi:[1,0]
    v_pk_fma_f32 v[112:113], v[114:115], v[68:69], v[112:113] op_sel:[1,1,0] op_sel_hi:[0,1,1] neg_lo:[1,0,0]
    v_cvt_pk_bf16_f32 v100, v112, v113
    ds_write_addtid_b32 v100 offset:7616
    v_pk_mul_f32 v[114:115], v[112:113], v[68:69] op_sel_hi:[1,0]
    v_pk_fma_f32 v[114:115], v[112:113], v[68:69], v[114:115] op_sel:[1,1,0] op_sel_hi:[0,1,1] neg_lo:[1,0,0]
    v_cvt_pk_bf16_f32 v101, v114, v115
    ds_write_addtid_b32 v101 offset:7888
    v_pk_mul_f32 v[112:113], v[114:115], v[68:69] op_sel_hi:[1,0]
    v_pk_fma_f32 v[112:113], v[114:115], v[68:69], v[112:113] op_sel:[1,1,0] op_sel_hi:[0,1,1] neg_lo:[1,0,0]
    v_cvt_pk_bf16_f32 v102, v112, v113
    ds_write_addtid_b32 v102 offset:8160
    v_pk_mul_f32 v[114:115], v[112:113], v[68:69] op_sel_hi:[1,0]
    v_pk_fma_f32 v[114:115], v[112:113], v[68:69], v[114:115] op_sel:[1,1,0] op_sel_hi:[0,1,1] neg_lo:[1,0,0]
    v_cvt_pk_bf16_f32 v103, v114, v115
    ds_write_addtid_b32 v103 offset:8432
    s_mov_b64 exec, 1
    ds_add_u32 v75, v74 offset:64
    s_mov_b64 exec, -1
    ds_read_b32 v1, v0 offset:40
    s_waitcnt lgkmcnt(0)
L_cq0:
    v_readfirstlane_b32 s42, v1
    s_nop 0
    s_cmp_eq_u32 s42, 1
    s_cbranch_scc1 L_rq0
    s_sleep 1
    ds_read_b32 v1, v0 offset:40
    s_waitcnt lgkmcnt(0)
    s_branch L_cq0
L_rq0:
    ds_read_b32 v1, v0 offset:44
    s_waitcnt lgkmcnt(0)
L_cq1:
    v_readfirstlane_b32 s42, v1
    s_nop 0
    s_cmp_eq_u32 s42, 1
    s_cbranch_scc1 L_rq1
    s_sleep 1
    ds_read_b32 v1, v0 offset:44
    s_waitcnt lgkmcnt(0)
    s_branch L_cq1
L_rq1:
    s_mov_b32 m0, s33
    v_mov_b32 v88, 0x3f80
    ds_write_addtid_b32 v88 offset:56000
    v_cvt_pk_bf16_f32 v89, v70, v71
    ds_write_addtid_b32 v89 offset:56272
    v_pk_mul_f32 v[112:113], v[70:71], v[70:71] op_sel_hi:[1,0]
    v_pk_fma_f32 v[112:113], v[70:71], v[70:71], v[112:113] op_sel:[1,1,0] op_sel_hi:[0,1,1] neg_lo:[1,0,0]
    v_cvt_pk_bf16_f32 v90, v112, v113
    ds_write_addtid_b32 v90 offset:56544
    v_pk_mul_f32 v[114:115], v[112:113], v[70:71] op_sel_hi:[1,0]
    v_pk_fma_f32 v[114:115], v[112:113], v[70:71], v[114:115] op_sel:[1,1,0] op_sel_hi:[0,1,1] neg_lo:[1,0,0]
    v_cvt_pk_bf16_f32 v91, v114, v115
    ds_write_addtid_b32 v91 offset:56816
    v_pk_mul_f32 v[112:113], v[114:115], v[70:71] op_sel_hi:[1,0]
    v_pk_fma_f32 v[112:113], v[114:115], v[70:71], v[112:113] op_sel:[1,1,0] op_sel_hi:[0,1,1] neg_lo:[1,0,0]
    v_cvt_pk_bf16_f32 v92, v112, v113
    ds_write_addtid_b32 v92 offset:57088
    v_pk_mul_f32 v[114:115], v[112:113], v[70:71] op_sel_hi:[1,0]
    v_pk_fma_f32 v[114:115], v[112:113], v[70:71], v[114:115] op_sel:[1,1,0] op_sel_hi:[0,1,1] neg_lo:[1,0,0]
    v_cvt_pk_bf16_f32 v93, v114, v115
    ds_write_addtid_b32 v93 offset:57360
    v_pk_mul_f32 v[112:113], v[114:115], v[70:71] op_sel_hi:[1,0]
    v_pk_fma_f32 v[112:113], v[114:115], v[70:71], v[112:113] op_sel:[1,1,0] op_sel_hi:[0,1,1] neg_lo:[1,0,0]
    v_cvt_pk_bf16_f32 v94, v112, v113
    ds_write_addtid_b32 v94 offset:57632
    v_pk_mul_f32 v[114:115], v[112:113], v[70:71] op_sel_hi:[1,0]
    v_pk_fma_f32 v[114:115], v[112:113], v[70:71], v[114:115] op_sel:[1,1,0] op_sel_hi:[0,1,1] neg_lo:[1,0,0]
    v_cvt_pk_bf16_f32 v95, v114, v115
    ds_write_addtid_b32 v95 offset:57904
    v_pk_mul_f32 v[112:113], v[114:115], v[70:71] op_sel_hi:[1,0]
    v_pk_fma_f32 v[112:113], v[114:115], v[70:71], v[112:113] op_sel:[1,1,0] op_sel_hi:[0,1,1] neg_lo:[1,0,0]
    v_cvt_pk_bf16_f32 v96, v112, v113
    ds_write_addtid_b32 v96 offset:58176
    v_pk_mul_f32 v[114:115], v[112:113], v[70:71] op_sel_hi:[1,0]
    v_pk_fma_f32 v[114:115], v[112:113], v[70:71], v[114:115] op_sel:[1,1,0] op_sel_hi:[0,1,1] neg_lo:[1,0,0]
    v_cvt_pk_bf16_f32 v97, v114, v115
    ds_write_addtid_b32 v97 offset:58448
    v_pk_mul_f32 v[112:113], v[114:115], v[70:71] op_sel_hi:[1,0]
    v_pk_fma_f32 v[112:113], v[114:115], v[70:71], v[112:113] op_sel:[1,1,0] op_sel_hi:[0,1,1] neg_lo:[1,0,0]
    v_cvt_pk_bf16_f32 v98, v112, v113
    ds_write_addtid_b32 v98 offset:58720
    v_pk_mul_f32 v[114:115], v[112:113], v[70:71] op_sel_hi:[1,0]
    v_pk_fma_f32 v[114:115], v[112:113], v[70:71], v[114:115] op_sel:[1,1,0] op_sel_hi:[0,1,1] neg_lo:[1,0,0]
    v_cvt_pk_bf16_f32 v99, v114, v115
    ds_write_addtid_b32 v99 offset:58992
    v_pk_mul_f32 v[112:113], v[114:115], v[70:71] op_sel_hi:[1,0]
    v_pk_fma_f32 v[112:113], v[114:115], v[70:71], v[112:113] op_sel:[1,1,0] op_sel_hi:[0,1,1] neg_lo:[1,0,0]
    v_cvt_pk_bf16_f32 v100, v112, v113
    ds_write_addtid_b32 v100 offset:59264
    v_pk_mul_f32 v[114:115], v[112:113], v[70:71] op_sel_hi:[1,0]
    v_pk_fma_f32 v[114:115], v[112:113], v[70:71], v[114:115] op_sel:[1,1,0] op_sel_hi:[0,1,1] neg_lo:[1,0,0]
    v_cvt_pk_bf16_f32 v101, v114, v115
    ds_write_addtid_b32 v101 offset:59536
    v_pk_mul_f32 v[112:113], v[114:115], v[70:71] op_sel_hi:[1,0]
    v_pk_fma_f32 v[112:113], v[114:115], v[70:71], v[112:113] op_sel:[1,1,0] op_sel_hi:[0,1,1] neg_lo:[1,0,0]
    v_cvt_pk_bf16_f32 v102, v112, v113
    ds_write_addtid_b32 v102 offset:59808
    v_pk_mul_f32 v[114:115], v[112:113], v[70:71] op_sel_hi:[1,0]
    v_pk_fma_f32 v[114:115], v[112:113], v[70:71], v[114:115] op_sel:[1,1,0] op_sel_hi:[0,1,1] neg_lo:[1,0,0]
    v_cvt_pk_bf16_f32 v103, v114, v115
    ds_write_addtid_b32 v103 offset:60080
    v_pk_mul_f32 v[112:113], v[114:115], v[70:71] op_sel_hi:[1,0]
    v_pk_fma_f32 v[112:113], v[114:115], v[70:71], v[112:113] op_sel:[1,1,0] op_sel_hi:[0,1,1] neg_lo:[1,0,0]
    v_cvt_pk_bf16_f32 v88, v112, v113
    ds_write_addtid_b32 v88 offset:60352
    v_pk_mul_f32 v[114:115], v[112:113], v[70:71] op_sel_hi:[1,0]
    v_pk_fma_f32 v[114:115], v[112:113], v[70:71], v[114:115] op_sel:[1,1,0] op_sel_hi:[0,1,1] neg_lo:[1,0,0]
    v_cvt_pk_bf16_f32 v89, v114, v115
    ds_write_addtid_b32 v89 offset:60624
    v_pk_mul_f32 v[112:113], v[114:115], v[70:71] op_sel_hi:[1,0]
    v_pk_fma_f32 v[112:113], v[114:115], v[70:71], v[112:113] op_sel:[1,1,0] op_sel_hi:[0,1,1] neg_lo:[1,0,0]
    v_cvt_pk_bf16_f32 v90, v112, v113
    ds_write_addtid_b32 v90 offset:60896
    v_pk_mul_f32 v[114:115], v[112:113], v[70:71] op_sel_hi:[1,0]
    v_pk_fma_f32 v[114:115], v[112:113], v[70:71], v[114:115] op_sel:[1,1,0] op_sel_hi:[0,1,1] neg_lo:[1,0,0]
    v_cvt_pk_bf16_f32 v91, v114, v115
    ds_write_addtid_b32 v91 offset:61168
    v_pk_mul_f32 v[112:113], v[114:115], v[70:71] op_sel_hi:[1,0]
    v_pk_fma_f32 v[112:113], v[114:115], v[70:71], v[112:113] op_sel:[1,1,0] op_sel_hi:[0,1,1] neg_lo:[1,0,0]
    v_cvt_pk_bf16_f32 v92, v112, v113
    ds_write_addtid_b32 v92 offset:61440
    v_pk_mul_f32 v[114:115], v[112:113], v[70:71] op_sel_hi:[1,0]
    v_pk_fma_f32 v[114:115], v[112:113], v[70:71], v[114:115] op_sel:[1,1,0] op_sel_hi:[0,1,1] neg_lo:[1,0,0]
    v_cvt_pk_bf16_f32 v93, v114, v115
    ds_write_addtid_b32 v93 offset:61712
    v_pk_mul_f32 v[112:113], v[114:115], v[70:71] op_sel_hi:[1,0]
    v_pk_fma_f32 v[112:113], v[114:115], v[70:71], v[112:113] op_sel:[1,1,0] op_sel_hi:[0,1,1] neg_lo:[1,0,0]
    v_cvt_pk_bf16_f32 v94, v112, v113
    ds_write_addtid_b32 v94 offset:61984
    v_pk_mul_f32 v[114:115], v[112:113], v[70:71] op_sel_hi:[1,0]
    v_pk_fma_f32 v[114:115], v[112:113], v[70:71], v[114:115] op_sel:[1,1,0] op_sel_hi:[0,1,1] neg_lo:[1,0,0]
    v_cvt_pk_bf16_f32 v95, v114, v115
    ds_write_addtid_b32 v95 offset:62256
    v_pk_mul_f32 v[112:113], v[114:115], v[70:71] op_sel_hi:[1,0]
    v_pk_fma_f32 v[112:113], v[114:115], v[70:71], v[112:113] op_sel:[1,1,0] op_sel_hi:[0,1,1] neg_lo:[1,0,0]
    v_cvt_pk_bf16_f32 v96, v112, v113
    ds_write_addtid_b32 v96 offset:62528
    v_pk_mul_f32 v[114:115], v[112:113], v[70:71] op_sel_hi:[1,0]
    v_pk_fma_f32 v[114:115], v[112:113], v[70:71], v[114:115] op_sel:[1,1,0] op_sel_hi:[0,1,1] neg_lo:[1,0,0]
    v_cvt_pk_bf16_f32 v97, v114, v115
    ds_write_addtid_b32 v97 offset:62800
    v_pk_mul_f32 v[112:113], v[114:115], v[70:71] op_sel_hi:[1,0]
    v_pk_fma_f32 v[112:113], v[114:115], v[70:71], v[112:113] op_sel:[1,1,0] op_sel_hi:[0,1,1] neg_lo:[1,0,0]
    v_cvt_pk_bf16_f32 v98, v112, v113
    ds_write_addtid_b32 v98 offset:63072
    v_pk_mul_f32 v[114:115], v[112:113], v[70:71] op_sel_hi:[1,0]
    v_pk_fma_f32 v[114:115], v[112:113], v[70:71], v[114:115] op_sel:[1,1,0] op_sel_hi:[0,1,1] neg_lo:[1,0,0]
    v_cvt_pk_bf16_f32 v99, v114, v115
    ds_write_addtid_b32 v99 offset:63344
    v_pk_mul_f32 v[112:113], v[114:115], v[70:71] op_sel_hi:[1,0]
    v_pk_fma_f32 v[112:113], v[114:115], v[70:71], v[112:113] op_sel:[1,1,0] op_sel_hi:[0,1,1] neg_lo:[1,0,0]
    v_cvt_pk_bf16_f32 v100, v112, v113
    ds_write_addtid_b32 v100 offset:63616
    v_pk_mul_f32 v[114:115], v[112:113], v[70:71] op_sel_hi:[1,0]
    v_pk_fma_f32 v[114:115], v[112:113], v[70:71], v[114:115] op_sel:[1,1,0] op_sel_hi:[0,1,1] neg_lo:[1,0,0]
    v_cvt_pk_bf16_f32 v101, v114, v115
    ds_write_addtid_b32 v101 offset:63888
    v_pk_mul_f32 v[112:113], v[114:115], v[70:71] op_sel_hi:[1,0]
    v_pk_fma_f32 v[112:113], v[114:115], v[70:71], v[112:113] op_sel:[1,1,0] op_sel_hi:[0,1,1] neg_lo:[1,0,0]
    v_cvt_pk_bf16_f32 v102, v112, v113
    ds_write_addtid_b32 v102 offset:64160
    v_pk_mul_f32 v[114:115], v[112:113], v[70:71] op_sel_hi:[1,0]
    v_pk_fma_f32 v[114:115], v[112:113], v[70:71], v[114:115] op_sel:[1,1,0] op_sel_hi:[0,1,1] neg_lo:[1,0,0]
    v_cvt_pk_bf16_f32 v103, v114, v115
    ds_write_addtid_b32 v103 offset:64432
    s_mov_b64 exec, 1
    ds_add_u32 v75, v74 offset:72
    s_mov_b64 exec, -1
    s_mov_b64 exec, 1
    ds_add_u32 v0, v74 offset:56
    s_mov_b64 exec, -1
    s_cmp_lg_u32 s59, 0
    s_cbranch_scc1 L_nub
    ds_read_b32 v1, v0 offset:36
    s_waitcnt lgkmcnt(0)
L_cla:
    v_readfirstlane_b32 s42, v1
    s_nop 0
    s_cmp_eq_u32 s42, 4
    s_cbranch_scc1 L_rla
    s_sleep 1
    ds_read_b32 v1, v0 offset:36
    s_waitcnt lgkmcnt(0)
    s_branch L_cla
L_rla:
    ds_read_b128 v[40:43], v20 offset:0
    ds_read_b128 v[44:47], v20 offset:1024
    ds_read_b128 v[48:51], v20 offset:2048
    ds_read_b128 v[52:55], v20 offset:3072
    ds_read_b128 v[56:59], v11 offset:448
    ds_read_b128 v[60:63], v11 offset:432
    ds_read_b128 v[64:67], v11 offset:960
    ds_read_b128 v[68:71], v11 offset:944
    ds_read_b128 v[144:147], v11 offset:1472
    ds_read_b128 v[148:151], v11 offset:1456
    ds_read_b128 v[152:155], v11 offset:1984
    ds_read_b128 v[156:159], v11 offset:1968
    v_add_u32 v15, 1310720, v15
    ds_read_b32 v1, v0 offset:56
    s_waitcnt lgkmcnt(0)
L_clg:
    v_readfirstlane_b32 s42, v1
    s_nop 0
    s_cmp_eq_u32 s42, 6
    s_cbranch_scc1 L_rlg
    s_sleep 1
    ds_read_b32 v1, v0 offset:56
    s_waitcnt lgkmcnt(0)
    s_branch L_clg
L_rlg:
    s_setprio 2
    v_mfma_f32_16x16x32_bf16 v[80:83], v[56:59], v[48:51], 0
    v_mfma_f32_16x16x32_bf16 v[84:87], v[56:59], v[52:55], 0
    v_mfma_f32_16x16x32_bf16 v[96:99], v[56:59], v[44:47], 0
    ds_read_b128 v[56:59], v11 offset:448
    v_mfma_f32_16x16x32_bf16 v[100:103], v[60:63], v[48:51], 0
    v_mfma_f32_16x16x32_bf16 v[104:107], v[60:63], v[52:55], 0
    v_mfma_f32_16x16x32_bf16 v[108:111], v[60:63], v[40:43], 0
    ds_read_b128 v[60:63], v11 offset:512
    s_nop 1
    v_cvt_pk_bf16_f32 v113, v80, v84
    v_cvt_pk_bf16_f32 v115, v81, v85
    v_cvt_pk_bf16_f32 v117, v82, v86
    v_cvt_pk_bf16_f32 v119, v83, v87
    v_mfma_f32_16x16x32_bf16 v[80:83], v[64:67], v[48:51], 0
    v_cvt_pk_bf16_f32 v112, v100, v104
    v_cvt_pk_bf16_f32 v114, v101, v105
    v_mfma_f32_16x16x32_bf16 v[84:87], v[64:67], v[52:55], 0
    v_cvt_pk_bf16_f32 v116, v102, v106
    v_cvt_pk_bf16_f32 v118, v103, v107
    v_mfma_f32_16x16x32_bf16 v[100:103], v[64:67], v[44:47], 0
    ds_read_b128 v[64:67], v11 offset:576
    v_cvt_pk_bf16_f32 v24, v108, v96
    v_cvt_pk_bf16_f32 v25, v109, v97
    v_cvt_pk_bf16_f32 v26, v110, v98
    v_cvt_pk_bf16_f32 v27, v111, v99
    v_mfma_f32_16x16x32_bf16 v[104:107], v[68:71], v[48:51], 0
    v_cvt_pk_bf16_f32 v121, v80, v84
    v_cvt_pk_bf16_f32 v123, v81, v85
    v_mfma_f32_16x16x32_bf16 v[108:111], v[68:71], v[52:55], 0
    v_cvt_pk_bf16_f32 v125, v82, v86
    v_cvt_pk_bf16_f32 v127, v83, v87
    v_mfma_f32_16x16x32_bf16 v[96:99], v[68:71], v[40:43], 0
    ds_read_b128 v[68:71], v11 offset:640
    v_mfma_f32_16x16x32_bf16 v[80:83], v[144:147], v[48:51], 0
    v_mfma_f32_16x16x32_bf16 v[84:87], v[144:147], v[52:55], 0
    s_nop 1
    v_cvt_pk_bf16_f32 v120, v104, v108
    v_cvt_pk_bf16_f32 v122, v105, v109
    v_cvt_pk_bf16_f32 v124, v106, v110
    v_cvt_pk_bf16_f32 v126, v107, v111
    v_cvt_pk_bf16_f32 v28, v96, v100
    v_cvt_pk_bf16_f32 v29, v97, v101
    v_cvt_pk_bf16_f32 v30, v98, v102
    v_cvt_pk_bf16_f32 v31, v99, v103
    v_mfma_f32_16x16x32_bf16 v[96:99], v[144:147], v[44:47], 0
    ds_read_b128 v[144:147], v11 offset:704
    v_cvt_pk_bf16_f32 v129, v80, v84
    v_mfma_f32_16x16x32_bf16 v[104:107], v[148:151], v[48:51], 0
    v_cvt_pk_bf16_f32 v131, v81, v85
    v_cvt_pk_bf16_f32 v133, v82, v86
    v_mfma_f32_16x16x32_bf16 v[108:111], v[148:151], v[52:55], 0
    v_cvt_pk_bf16_f32 v135, v83, v87
    v_mfma_f32_16x16x32_bf16 v[100:103], v[148:151], v[40:43], 0
    ds_read_b128 v[148:151], v11 offset:768
    v_mfma_f32_16x16x32_bf16 v[80:83], v[152:155], v[48:51], 0
    v_mfma_f32_16x16x32_bf16 v[84:87], v[152:155], v[52:55], 0
    s_nop 2
    v_cvt_pk_bf16_f32 v128, v104, v108
    v_cvt_pk_bf16_f32 v130, v105, v109
    v_cvt_pk_bf16_f32 v132, v106, v110
    v_cvt_pk_bf16_f32 v134, v107, v111
    v_cvt_pk_bf16_f32 v32, v100, v96
    v_cvt_pk_bf16_f32 v33, v101, v97
    v_cvt_pk_bf16_f32 v34, v102, v98
    v_cvt_pk_bf16_f32 v35, v103, v99
    v_mfma_f32_16x16x32_bf16 v[100:103], v[152:155], v[44:47], 0
    ds_read_b128 v[152:155], v11 offset:832
    v_cvt_pk_bf16_f32 v137, v80, v84
    v_mfma_f32_16x16x32_bf16 v[104:107], v[156:159], v[48:51], 0
    v_cvt_pk_bf16_f32 v139, v81, v85
    v_cvt_pk_bf16_f32 v141, v82, v86
    v_mfma_f32_16x16x32_bf16 v[108:111], v[156:159], v[52:55], 0
    v_cvt_pk_bf16_f32 v143, v83, v87
    v_mfma_f32_16x16x32_bf16 v[96:99], v[156:159], v[40:43], 0
    ds_read_b128 v[156:159], v11 offset:896
    ds_read_b32 v1, v0 offset:48
    s_waitcnt lgkmcnt(0)
L_ck:
    v_readfirstlane_b32 s42, v1
    s_nop 0
    s_cmp_eq_u32 s42, 2
    s_cbranch_scc1 L_rk
    s_sleep 1
    ds_read_b32 v1, v0 offset:48
    s_waitcnt lgkmcnt(0)
    s_branch L_ck
L_rk:
    ds_read2_b32 v[248:249], v16 offset0:0 offset1:1
    ds_read2_b32 v[250:251], v16 offset0:2 offset1:3
    ds_read2_b32 v[244:245], v17 offset0:0 offset1:1
    ds_read2_b32 v[246:247], v17 offset0:2 offset1:3
    ds_read2_b32 v[240:241], v17 offset0:16 offset1:17
    ds_read2_b32 v[242:243], v17 offset0:18 offset1:19
    ds_read2_b32 v[236:237], v17 offset0:32 offset1:33
    ds_read2_b32 v[238:239], v17 offset0:34 offset1:35
    ds_read2_b32 v[232:233], v17 offset0:48 offset1:49
    ds_read2_b32 v[234:235], v17 offset0:50 offset1:51
    ds_read2_b32 v[228:229], v17 offset0:64 offset1:65
    ds_read2_b32 v[230:231], v17 offset0:66 offset1:67
    ds_read2_b32 v[224:225], v17 offset0:80 offset1:81
    ds_read2_b32 v[226:227], v17 offset0:82 offset1:83
    ds_read2_b32 v[220:221], v17 offset0:96 offset1:97
    ds_read2_b32 v[222:223], v17 offset0:98 offset1:99
    ds_read2_b32 v[216:217], v17 offset0:112 offset1:113
    ds_read2_b32 v[218:219], v17 offset0:114 offset1:115
    s_waitcnt vmcnt(0)
    v_perm_b32 v192, v164, v160, s38
    v_perm_b32 v193, v172, v168, s38
    v_perm_b32 v194, v180, v176, s38
    v_perm_b32 v195, v188, v184, s38
    ds_write_b128 v7, v[192:195] offset:2048
    v_perm_b32 v196, v164, v160, s39
    v_perm_b32 v197, v172, v168, s39
    v_perm_b32 v198, v180, v176, s39
    v_perm_b32 v199, v188, v184, s39
    ds_write_b128 v7, v[196:199] offset:6624
    v_perm_b32 v192, v165, v161, s38
    v_perm_b32 v193, v173, v169, s38
    v_perm_b32 v194, v181, v177, s38
    v_perm_b32 v195, v189, v185, s38
    ds_write_b128 v7, v[192:195] offset:11200
    v_perm_b32 v196, v165, v161, s39
    v_perm_b32 v197, v173, v169, s39
    v_perm_b32 v198, v181, v177, s39
    v_perm_b32 v199, v189, v185, s39
    ds_write_b128 v7, v[196:199] offset:15776
    v_perm_b32 v192, v166, v162, s38
    v_perm_b32 v193, v174, v170, s38
    v_perm_b32 v194, v182, v178, s38
    v_perm_b32 v195, v190, v186, s38
    ds_write_b128 v7, v[192:195] offset:20352
    v_perm_b32 v196, v166, v162, s39
    v_perm_b32 v197, v174, v170, s39
    v_perm_b32 v198, v182, v178, s39
    v_perm_b32 v199, v190, v186, s39
    ds_write_b128 v7, v[196:199] offset:24928
    s_mov_b64 exec, 1
    ds_add_u32 v0, v74 offset:32
    s_mov_b64 exec, -1
    s_waitcnt lgkmcnt(14)
    v_mfma_f32_16x16x32_bf16 v[88:91], v[248:251], v[56:59], 0
    ds_read_b128 v[56:59], v11 offset:960
    v_cvt_pk_bf16_f32 v136, v104, v108
    s_waitcnt lgkmcnt(14)
    v_mfma_f32_16x16x32_bf16 v[88:91], v[244:247], v[60:63], v[88:91]
    ds_read_b128 v[60:63], v11 offset:1024
    v_cvt_pk_bf16_f32 v138, v105, v109
    s_waitcnt lgkmcnt(14)
    v_mfma_f32_16x16x32_bf16 v[88:91], v[240:243], v[64:67], v[88:91]
    ds_read_b128 v[64:67], v11 offset:1088
    v_cvt_pk_bf16_f32 v140, v106, v110
    s_waitcnt lgkmcnt(14)
    v_mfma_f32_16x16x32_bf16 v[88:91], v[236:239], v[68:71], v[88:91]
    ds_read_b128 v[68:71], v11 offset:1152
    v_cvt_pk_bf16_f32 v142, v107, v111
    ds_read_b64 v[160:161], v19 offset:256
    ds_read_b64 v[162:163], v19 offset:264
    s_waitcnt lgkmcnt(14)
    v_mfma_f32_16x16x32_bf16 v[88:91], v[232:235], v[144:147], v[88:91]
    ds_read_b128 v[144:147], v11 offset:1216
    v_cvt_pk_bf16_f32 v36, v96, v100
    ds_read2_b32 v[212:213], v17 offset0:128 offset1:129
    ds_read2_b32 v[214:215], v17 offset0:130 offset1:131
    s_waitcnt lgkmcnt(14)
    v_mfma_f32_16x16x32_bf16 v[88:91], v[228:231], v[148:151], v[88:91]
    ds_read_b128 v[148:151], v11 offset:1280
    v_cvt_pk_bf16_f32 v37, v97, v101
    ds_read2_b32 v[208:209], v17 offset0:144 offset1:145
    ds_read2_b32 v[210:211], v17 offset0:146 offset1:147
    s_waitcnt lgkmcnt(14)
    v_mfma_f32_16x16x32_bf16 v[88:91], v[224:227], v[152:155], v[88:91]
    ds_read_b128 v[152:155], v11 offset:1344
    v_cvt_pk_bf16_f32 v38, v98, v102
    ds_read2_b32 v[204:205], v17 offset0:160 offset1:161
    ds_read2_b32 v[206:207], v17 offset0:162 offset1:163
    s_waitcnt lgkmcnt(14)
    v_mfma_f32_16x16x32_bf16 v[88:91], v[220:223], v[156:159], v[88:91]
    ds_read_b128 v[156:159], v11 offset:1408
    s_waitcnt lgkmcnt(14)
    v_mfma_f32_16x16x32_bf16 v[88:91], v[216:219], v[56:59], v[88:91]
    ds_read2_b32 v[200:201], v17 offset0:176 offset1:177
    ds_read2_b32 v[202:203], v17 offset0:178 offset1:179
    v_mfma_f32_16x16x32_bf16 v[92:95], v[248:251], v[56:59], 0
    ds_read_b128 v[56:59], v11 offset:1472
    v_cvt_pk_bf16_f32 v39, v99, v103
    s_waitcnt lgkmcnt(13)
    v_mfma_f32_16x16x32_bf16 v[88:91], v[112:115], v[160:163], v[88:91]
    ds_read_b64 v[164:165], v19 offset:272
    ds_read_b64 v[166:167], v19 offset:280
    s_waitcnt lgkmcnt(12)
    v_mfma_f32_16x16x32_bf16 v[88:91], v[212:215], v[60:63], v[88:91]
    v_mov_b32 v2, s40
    ds_read_b128 v[252:255], v20 offset:4096
    v_mfma_f32_16x16x32_bf16 v[92:95], v[244:247], v[60:63], v[92:95]
    ds_read_b128 v[60:63], v11 offset:1536
    ds_read_u16 v2, v2 offset:2592
    s_waitcnt lgkmcnt(12)
    v_mfma_f32_16x16x32_bf16 v[88:91], v[208:211], v[64:67], v[88:91]
    ds_read2_b32 v[196:197], v17 offset0:192 offset1:193
    ds_read2_b32 v[198:199], v17 offset0:194 offset1:195
    v_mfma_f32_16x16x32_bf16 v[92:95], v[240:243], v[64:67], v[92:95]
    ds_read_b128 v[64:67], v11 offset:1600
    s_waitcnt lgkmcnt(3)
    v_mfma_f32_16x16x32_bf16 v[88:91], v[204:207], v[68:71], v[88:91]
    ds_read2_b32 v[192:193], v17 offset0:208 offset1:209
    ds_read2_b32 v[194:195], v17 offset0:210 offset1:211
    v_mfma_f32_16x16x32_bf16 v[92:95], v[236:239], v[68:71], v[92:95]
    ds_read_b128 v[68:71], v11 offset:1664
    v_lshl_or_b32 v2, v2, 16, v2
    v_mfma_f32_16x16x32_bf16 v[88:91], v[200:203], v[144:147], v[88:91]
    ds_read2_b32 v[188:189], v17 offset0:224 offset1:225
    ds_read2_b32 v[190:191], v17 offset0:226 offset1:227
    v_mfma_f32_16x16x32_bf16 v[92:95], v[232:235], v[144:147], v[92:95]
    ds_read_b128 v[144:147], v11 offset:1728
    v_and_b32 v252, v2, v252
    v_mfma_f32_16x16x32_bf16 v[88:91], v[116:119], v[164:167], v[88:91]
    ds_read2_b32 v[184:185], v17 offset0:240 offset1:241
    ds_read2_b32 v[186:187], v17 offset0:242 offset1:243
    s_waitcnt lgkmcnt(9)
    v_mfma_f32_16x16x32_bf16 v[88:91], v[196:199], v[148:151], v[88:91]
    v_and_b32 v253, v2, v253
    v_and_b32 v254, v2, v254
    v_mfma_f32_16x16x32_bf16 v[92:95], v[228:231], v[148:151], v[92:95]
    ds_read_b32 v1, v0 offset:32
    ds_read_b128 v[148:151], v11 offset:1792
    s_waitcnt lgkmcnt(8)
    v_mfma_f32_16x16x32_bf16 v[88:91], v[192:195], v[152:155], v[88:91]
    ds_read_b64 v[168:169], v19 offset:128
    ds_read_b64 v[170:171], v19 offset:136
    v_mfma_f32_16x16x32_bf16 v[92:95], v[224:227], v[152:155], v[92:95]
    ds_read_b128 v[152:155], v11 offset:1856
    v_and_b32 v255, v2, v255
    s_waitcnt lgkmcnt(8)
    v_mfma_f32_16x16x32_bf16 v[88:91], v[188:191], v[156:159], v[88:91]
    ds_read_b64 v[172:173], v19 offset:144
    ds_read_b64 v[174:175], v19 offset:152
    v_mfma_f32_16x16x32_bf16 v[92:95], v[220:223], v[156:159], v[92:95]
    ds_read_b128 v[156:159], v11 offset:1920
    s_waitcnt lgkmcnt(8)
    v_mfma_f32_16x16x32_bf16 v[88:91], v[184:187], v[56:59], v[88:91]
    v_mfma_f32_16x16x32_bf16 v[92:95], v[216:219], v[56:59], v[92:95]
    v_mfma_f32_16x16x32_bf16 v[104:107], v[252:255], v[56:59], 0
    ds_read_b128 v[56:59], v11 offset:1984
    s_waitcnt lgkmcnt(5)
    v_mfma_f32_16x16x32_bf16 v[92:95], v[112:115], v[168:171], v[92:95]
    v_mfma_f32_16x16x32_bf16 v[92:95], v[212:215], v[60:63], v[92:95]
    v_mfma_f32_16x16x32_bf16 v[92:95], v[208:211], v[64:67], v[92:95]
    s_waitcnt lgkmcnt(2)
    v_mfma_f32_16x16x32_bf16 v[92:95], v[116:119], v[172:175], v[92:95]
    v_cvt_pk_bf16_f32 v22, v88, v89
    v_cvt_pk_bf16_f32 v23, v90, v91
    v_mfma_f32_16x16x32_bf16 v[92:95], v[204:207], v[68:71], v[92:95]
    ds_write_b64 v13, v[22:23] offset:1280
    s_mov_b64 exec, 1
    ds_add_u32 v0, v74 offset:8
    s_mov_b64 exec, -1
    ds_read_b32 v21, v0 offset:8
    s_waitcnt lgkmcnt(0)
L_ct2:
    v_readfirstlane_b32 s42, v21
    s_nop 0
    s_cmp_eq_u32 s42, 6
    s_cbranch_scc1 L_rt2
    ds_read_b32 v21, v0 offset:8
    s_waitcnt lgkmcnt(0)
    s_branch L_ct2
L_rt2:
    ds_read_b64_tr_b16 v[76:77], v14 offset:1280
    ds_read_b64_tr_b16 v[78:79], v14 offset:36352
    ds_read_b64_tr_b16 v[4:5], v14 offset:1440
    ds_read_b64_tr_b16 v[6:7], v14 offset:36512
    v_mfma_f32_16x16x32_bf16 v[92:95], v[200:203], v[144:147], v[92:95]
    v_mfma_f32_16x16x32_bf16 v[92:95], v[120:123], v[160:163], v[92:95]
    v_mfma_f32_16x16x32_bf16 v[92:95], v[196:199], v[148:151], v[92:95]
L_cbh:
    v_readfirstlane_b32 s43, v1
    s_nop 0
    s_cmp_eq_u32 s43, 2
    s_cbranch_scc1 L_rbh
    ds_read_b32 v1, v0 offset:32
    s_waitcnt lgkmcnt(0)
    s_branch L_cbh
L_rbh:
    ds_read_b128 v[60:63], v11 offset:2496
    v_mfma_f32_16x16x32_bf16 v[92:95], v[192:195], v[152:155], v[92:95]
    s_waitcnt lgkmcnt(1)
    global_store_dwordx3 v15, v[76:78], s[34:35]
    global_store_dwordx3 v15, v[4:6], s[54:55]
    v_add_u32 v15, 655360, v15
    v_mfma_f32_16x16x32_bf16 v[92:95], v[124:127], v[164:167], v[92:95]
    ds_read_b128 v[64:67], v11 offset:2560
    ds_read_b128 v[68:71], v11 offset:2624
    v_mfma_f32_16x16x32_bf16 v[92:95], v[188:191], v[156:159], v[92:95]
    ds_read_b128 v[144:147], v11 offset:2688
    ds_read_b128 v[148:151], v11 offset:2480
    v_mfma_f32_16x16x32_bf16 v[92:95], v[184:187], v[56:59], v[92:95]
    ds_read_b128 v[152:155], v11 offset:2752
    ds_read_b128 v[156:159], v11 offset:2816
    v_mfma_f32_16x16x32_bf16 v[108:111], v[252:255], v[56:59], 0
    ds_read_b128 v[56:59], v11 offset:2880
    s_waitcnt lgkmcnt(6)
    v_mfma_f32_16x16x32_bf16 v[104:107], v[248:251], v[60:63], v[104:107]
    v_mfma_f32_16x16x32_bf16 v[88:91], v[60:63], v[48:51], 0
    v_mfma_f32_16x16x32_bf16 v[80:83], v[60:63], v[52:55], 0
    v_cvt_pk_bf16_f32 v22, v92, v93
    v_cvt_pk_bf16_f32 v23, v94, v95
    v_mfma_f32_16x16x32_bf16 v[104:107], v[244:247], v[64:67], v[104:107]
    ds_write_b64 v13, v[22:23] offset:1920
    s_waitcnt lgkmcnt(5)
    v_mfma_f32_16x16x32_bf16 v[104:107], v[240:243], v[68:71], v[104:107]
    s_mov_b64 exec, 1
    ds_add_u32 v0, v74 offset:12
    s_mov_b64 exec, -1
    ds_read_b32 v21, v0 offset:12
    s_waitcnt lgkmcnt(0)
L_ct3:
    v_readfirstlane_b32 s42, v21
    s_nop 0
    s_cmp_eq_u32 s42, 6
    s_cbranch_scc1 L_rt3
    ds_read_b32 v21, v0 offset:12
    s_waitcnt lgkmcnt(0)
    s_branch L_ct3
L_rt3:
    ds_read_b64_tr_b16 v[76:77], v14 offset:1920
    ds_read_b64_tr_b16 v[78:79], v14 offset:36992
    ds_read_b64_tr_b16 v[4:5], v14 offset:2080
    ds_read_b64_tr_b16 v[6:7], v14 offset:37152
    v_mfma_f32_16x16x32_bf16 v[104:107], v[236:239], v[144:147], v[104:107]
    ds_read_b128 v[60:63], v11 offset:2944
    ds_read_b128 v[64:67], v11 offset:3008
    v_mfma_f32_16x16x32_bf16 v[92:95], v[148:151], v[48:51], 0
    ds_read_b128 v[68:71], v11 offset:3072
    ds_read_b128 v[144:147], v11 offset:3136
    v_mfma_f32_16x16x32_bf16 v[84:87], v[148:151], v[52:55], 0
    ds_read_b128 v[148:151], v11 offset:3200
    s_waitcnt lgkmcnt(5)
    global_store_dwordx3 v15, v[76:78], s[34:35]
    global_store_dwordx3 v15, v[4:6], s[54:55]
    v_add_u32 v15, 1966080, v15
    s_setprio 0
    v_mfma_f32_16x16x32_bf16 v[104:107], v[232:235], v[152:155], v[104:107]
    ds_read_b64 v[180:181], v19 offset:16
    ds_read_b64 v[182:183], v19 offset:24
    v_mfma_f32_16x16x32_bf16 v[104:107], v[228:231], v[156:159], v[104:107]
    ds_read_b64 v[176:177], v19 offset:0
    ds_read_b64 v[178:179], v19 offset:8
    v_mfma_f32_16x16x32_bf16 v[104:107], v[224:227], v[56:59], v[104:107]
    ds_read_b128 v[152:155], v11 offset:2992
    s_waitcnt lgkmcnt(8)
    v_mfma_f32_16x16x32_bf16 v[104:107], v[220:223], v[60:63], v[104:107]
    ds_read_b128 v[156:159], v11 offset:3264
    ds_read_b128 v[56:59], v11 offset:3328
    v_mfma_f32_16x16x32_bf16 v[104:107], v[216:219], v[64:67], v[104:107]
    ds_read_b128 v[60:63], v11 offset:3392
    v_cvt_pk_bf16_f32 v113, v88, v80
    v_mfma_f32_16x16x32_bf16 v[108:111], v[248:251], v[64:67], v[108:111]
    v_cvt_pk_bf16_f32 v115, v89, v81
    v_cvt_pk_bf16_f32 v117, v90, v82
    v_mfma_f32_16x16x32_bf16 v[96:99], v[64:67], v[48:51], 0
    v_cvt_pk_bf16_f32 v119, v91, v83
    v_cvt_pk_bf16_f32 v112, v92, v84
    v_mfma_f32_16x16x32_bf16 v[100:103], v[64:67], v[52:55], 0
    ds_read_b128 v[64:67], v11 offset:3456
    s_waitcnt lgkmcnt(10)
    s_waitcnt lgkmcnt(7)
    v_mfma_f32_16x16x32_bf16 v[104:107], v[132:135], v[180:183], v[104:107]
    v_cvt_pk_bf16_f32 v114, v93, v85
    v_cvt_pk_bf16_f32 v116, v94, v86
    s_waitcnt lgkmcnt(5)
    v_mfma_f32_16x16x32_bf16 v[104:107], v[128:131], v[176:179], v[104:107]
    v_cvt_pk_bf16_f32 v118, v95, v87
    v_cvt_pk_bf16_f32 v121, v96, v100
    v_mfma_f32_16x16x32_bf16 v[104:107], v[212:215], v[68:71], v[104:107]
    v_cvt_pk_bf16_f32 v123, v97, v101
    v_cvt_pk_bf16_f32 v125, v98, v102
    v_mfma_f32_16x16x32_bf16 v[108:111], v[244:247], v[68:71], v[108:111]
    ds_read_b128 v[68:71], v11 offset:3520
    v_cvt_pk_bf16_f32 v127, v99, v103
    v_mfma_f32_16x16x32_bf16 v[104:107], v[136:139], v[168:171], v[104:107]
    ds_read2_b32 v[40:41], v18 offset0:48 offset1:49
    ds_read2_b32 v[42:43], v18 offset0:50 offset1:51
    v_mfma_f32_16x16x32_bf16 v[104:107], v[208:211], v[144:147], v[104:107]
    v_mfma_f32_16x16x32_bf16 v[108:111], v[240:243], v[144:147], v[108:111]
    ds_read_b128 v[144:147], v11 offset:3584
    v_mfma_f32_16x16x32_bf16 v[104:107], v[140:143], v[172:175], v[104:107]
    ds_read2_b32 v[44:45], v18 offset0:32 offset1:33
    ds_read2_b32 v[46:47], v18 offset0:34 offset1:35
    v_mfma_f32_16x16x32_bf16 v[104:107], v[204:207], v[148:151], v[104:107]
    v_mfma_f32_16x16x32_bf16 v[108:111], v[236:239], v[148:151], v[108:111]
    ds_read_b128 v[148:151], v11 offset:3648
    s_waitcnt lgkmcnt(10)
    v_mfma_f32_16x16x32_bf16 v[88:91], v[152:155], v[48:51], 0
    v_mfma_f32_16x16x32_bf16 v[80:83], v[152:155], v[52:55], 0
    ds_read_b128 v[152:155], v11 offset:3712
    v_mfma_f32_16x16x32_bf16 v[104:107], v[112:115], v[160:163], v[104:107]
    ds_read2_b32 v[48:49], v18 offset0:16 offset1:17
    ds_read2_b32 v[50:51], v18 offset0:18 offset1:19
    v_mfma_f32_16x16x32_bf16 v[104:107], v[200:203], v[156:159], v[104:107]
    v_mfma_f32_16x16x32_bf16 v[108:111], v[232:235], v[156:159], v[108:111]
    ds_read_b128 v[156:159], v11 offset:3776
    s_waitcnt lgkmcnt(12)
    v_mfma_f32_16x16x32_bf16 v[104:107], v[116:119], v[164:167], v[104:107]
    v_cvt_pk_bf16_f32 v120, v88, v80
    v_cvt_pk_bf16_f32 v122, v89, v81
    v_mfma_f32_16x16x32_bf16 v[104:107], v[196:199], v[56:59], v[104:107]
    v_cvt_pk_bf16_f32 v124, v90, v82
    v_cvt_pk_bf16_f32 v126, v91, v83
    v_mfma_f32_16x16x32_bf16 v[108:111], v[228:231], v[56:59], v[108:111]
    ds_read_b128 v[56:59], v11 offset:3840
    s_waitcnt lgkmcnt(9)
    v_mfma_f32_16x16x32_bf16 v[104:107], v[32:35], v[40:43], v[104:107]
    v_mfma_f32_16x16x32_bf16 v[104:107], v[192:195], v[60:63], v[104:107]
    v_mfma_f32_16x16x32_bf16 v[108:111], v[224:227], v[60:63], v[108:111]
    ds_read_b128 v[60:63], v11 offset:3904
    s_waitcnt lgkmcnt(7)
    v_mfma_f32_16x16x32_bf16 v[104:107], v[28:31], v[44:47], v[104:107]
    v_mfma_f32_16x16x32_bf16 v[104:107], v[188:191], v[64:67], v[104:107]
    v_mfma_f32_16x16x32_bf16 v[108:111], v[220:223], v[64:67], v[108:111]
    ds_read_b128 v[64:67], v11 offset:3968
    s_waitcnt lgkmcnt(4)
    v_mfma_f32_16x16x32_bf16 v[104:107], v[24:27], v[48:51], v[104:107]
    v_mfma_f32_16x16x32_bf16 v[104:107], v[184:187], v[68:71], v[104:107]
    v_mfma_f32_16x16x32_bf16 v[108:111], v[216:219], v[68:71], v[108:111]
    ds_read_b128 v[68:71], v11 offset:4032
    v_mfma_f32_16x16x32_bf16 v[108:111], v[140:143], v[180:183], v[108:111]
    v_mfma_f32_16x16x32_bf16 v[108:111], v[136:139], v[176:179], v[108:111]
    v_mfma_f32_16x16x32_bf16 v[108:111], v[212:215], v[144:147], v[108:111]
    v_mfma_f32_16x16x32_bf16 v[108:111], v[112:115], v[168:171], v[108:111]
    v_mfma_f32_16x16x32_bf16 v[108:111], v[208:211], v[148:151], v[108:111]
    v_mfma_f32_16x16x32_bf16 v[108:111], v[116:119], v[172:175], v[108:111]
    v_cvt_pk_bf16_f32 v22, v104, v105
    v_cvt_pk_bf16_f32 v23, v106, v107
    v_mfma_f32_16x16x32_bf16 v[108:111], v[204:207], v[152:155], v[108:111]
    ds_write_b64 v13, v[22:23] offset:3840
    s_waitcnt lgkmcnt(4)
    v_mfma_f32_16x16x32_bf16 v[108:111], v[120:123], v[160:163], v[108:111]
    s_mov_b64 exec, 1
    ds_add_u32 v0, v74 offset:24
    s_mov_b64 exec, -1
    ds_read_b32 v21, v0 offset:24
    s_waitcnt lgkmcnt(0)
L_ct6:
    v_readfirstlane_b32 s42, v21
    s_nop 0
    s_cmp_eq_u32 s42, 6
    s_cbranch_scc1 L_rt6
    ds_read_b32 v21, v0 offset:24
    s_waitcnt lgkmcnt(0)
    s_branch L_ct6
L_rt6:
    ds_read_b64_tr_b16 v[76:77], v14 offset:3840
    ds_read_b64_tr_b16 v[78:79], v14 offset:38912
    ds_read_b64_tr_b16 v[4:5], v14 offset:4000
    ds_read_b64_tr_b16 v[6:7], v14 offset:39072
    v_mfma_f32_16x16x32_bf16 v[108:111], v[200:203], v[156:159], v[108:111]
    ds_read2_b32 v[52:53], v18 offset0:0 offset1:1
    ds_read2_b32 v[54:55], v18 offset0:2 offset1:3
    v_mfma_f32_16x16x32_bf16 v[108:111], v[36:39], v[40:43], v[108:111]
    v_mfma_f32_16x16x32_bf16 v[108:111], v[124:127], v[164:167], v[108:111]
    v_mfma_f32_16x16x32_bf16 v[108:111], v[196:199], v[56:59], v[108:111]
    v_mfma_f32_16x16x32_bf16 v[108:111], v[32:35], v[44:47], v[108:111]
    v_mfma_f32_16x16x32_bf16 v[108:111], v[192:195], v[60:63], v[108:111]
    s_waitcnt lgkmcnt(2)
    global_store_dwordx3 v15, v[76:78], s[34:35]
    global_store_dwordx3 v15, v[4:6], s[54:55]
    v_add_u32 v15, 655360, v15
    v_mfma_f32_16x16x32_bf16 v[108:111], v[28:31], v[48:51], v[108:111]
    v_mfma_f32_16x16x32_bf16 v[108:111], v[188:191], v[64:67], v[108:111]
    s_waitcnt lgkmcnt(0)
    v_mfma_f32_16x16x32_bf16 v[108:111], v[24:27], v[52:55], v[108:111]
    v_mfma_f32_16x16x32_bf16 v[108:111], v[184:187], v[68:71], v[108:111]
    s_nop 7
    v_cvt_pk_bf16_f32 v22, v108, v109
    v_cvt_pk_bf16_f32 v23, v110, v111
    ds_write_b64 v13, v[22:23] offset:4480
    s_mov_b64 exec, 1
    ds_add_u32 v0, v74 offset:28
    s_mov_b64 exec, -1
    ds_read_b32 v21, v0 offset:28
    s_waitcnt lgkmcnt(0)
L_ct7:
    v_readfirstlane_b32 s42, v21
    s_nop 0
    s_cmp_eq_u32 s42, 6
    s_cbranch_scc1 L_rt7
    ds_read_b32 v21, v0 offset:28
    s_waitcnt lgkmcnt(0)
    s_branch L_ct7
L_rt7:
    ds_read_b64_tr_b16 v[76:77], v14 offset:4480
    ds_read_b64_tr_b16 v[78:79], v14 offset:39552
    ds_read_b64_tr_b16 v[4:5], v14 offset:4640
    ds_read_b64_tr_b16 v[6:7], v14 offset:39712
    s_waitcnt lgkmcnt(0)
    global_store_dwordx3 v15, v[76:78], s[34:35]
    global_store_dwordx3 v15, v[4:6], s[54:55]
    s_branch L_fin
L_nub:
    s_waitcnt vmcnt(0)
    v_perm_b32 v192, v164, v160, s38
    v_perm_b32 v193, v172, v168, s38
    v_perm_b32 v194, v180, v176, s38
    v_perm_b32 v195, v188, v184, s38
    ds_write_b128 v7, v[192:195] offset:2048
    v_perm_b32 v196, v164, v160, s39
    v_perm_b32 v197, v172, v168, s39
    v_perm_b32 v198, v180, v176, s39
    v_perm_b32 v199, v188, v184, s39
    ds_write_b128 v7, v[196:199] offset:6624
    v_perm_b32 v192, v165, v161, s38
    v_perm_b32 v193, v173, v169, s38
    v_perm_b32 v194, v181, v177, s38
    v_perm_b32 v195, v189, v185, s38
    ds_write_b128 v7, v[192:195] offset:11200
    v_perm_b32 v196, v165, v161, s39
    v_perm_b32 v197, v173, v169, s39
    v_perm_b32 v198, v181, v177, s39
    v_perm_b32 v199, v189, v185, s39
    ds_write_b128 v7, v[196:199] offset:15776
    v_perm_b32 v192, v166, v162, s38
    v_perm_b32 v193, v174, v170, s38
    v_perm_b32 v194, v182, v178, s38
    v_perm_b32 v195, v190, v186, s38
    ds_write_b128 v7, v[192:195] offset:20352
    v_perm_b32 v196, v166, v162, s39
    v_perm_b32 v197, v174, v170, s39
    v_perm_b32 v198, v182, v178, s39
    v_perm_b32 v199, v190, v186, s39
    ds_write_b128 v7, v[196:199] offset:24928
    s_mov_b64 exec, 1
    ds_add_u32 v0, v74 offset:32
    s_mov_b64 exec, -1
    s_branch L_fin
L_nst:
    s_mov_b32 s43, 8
L_nl:
    ds_read_b32 v21, v0 offset:0
    s_waitcnt lgkmcnt(0)
L_cns:
    v_readfirstlane_b32 s42, v21
    s_nop 0
    s_cmp_eq_u32 s42, 4
    s_cbranch_scc1 L_rns
    s_sleep 2
    ds_read_b32 v21, v0 offset:0
    s_waitcnt lgkmcnt(0)
    s_branch L_cns
L_rns:
    ds_read_b64_tr_b16 v[76:77], v14
    ds_read_b64_tr_b16 v[78:79], v14 offset:160
    v_add_u32 v0, 4, v0
    v_add_u32 v14, 640, v14
    s_waitcnt lgkmcnt(0)
    global_store_dwordx2 v15, v[76:77], s[34:35]
    global_store_dwordx2 v15, v[78:79], s[54:55]
    v_add_u32 v15, 655360, v15
    s_sub_u32 s43, s43, 1
    s_cmp_lg_u32 s43, 0
    s_cbranch_scc1 L_nl
L_fin:
L_end:
    s_endpgm
.section .rodata,"a"
.p2align 6
.amdhsa_kernel concat_heads__ssm_conv_s4d__ssm_conv_s4__prompt_kernel
  .amdhsa_next_free_vgpr 256
  .amdhsa_next_free_sgpr 102
  .amdhsa_accum_offset 256
  .amdhsa_group_segment_fixed_size 0
  .amdhsa_kernarg_size 152
  .amdhsa_user_sgpr_count 2
  .amdhsa_user_sgpr_kernarg_segment_ptr 1
  .amdhsa_system_sgpr_workgroup_id_x 1
.end_amdhsa_kernel
```
